```python
import torch

def _softmax(x, axis=-1):
    return torch.softmax(x, dim=axis)
def _gelu(x):
    return torch.nn.functional.gelu(x, approximate="tanh")
def _silu(x):
    return torch.nn.functional.silu(x)
def _sigmoid(x):
    return torch.sigmoid(x)
def _layernorm(x, axis=-1, eps=1e-5):
    m = x.mean(dim=axis, keepdim=True)
    v = x.var(dim=axis, keepdim=True, unbiased=False)
    return (x - m) / torch.sqrt(v + eps)
def _scatter_add(tgt, idx, src, axis=0):
    return tgt.clone().index_add_(axis, idx, src)
def _segment_sum(src, seg, n):
    out = torch.zeros((n,) + src.shape[1:], dtype=src.dtype)
    return out.index_add_(0, seg, src)
def _pad(x, pw):
    flat = tuple(v for pair in reversed(pw) for v in pair)
    return torch.nn.functional.pad(x, flat)

kernel_name = 'recurrent_scan__gqa_block_cached__glu_gated_swiglu__decode'

def setup_inputs():

    _w = (lambda a: (lambda t: t.to(torch.bfloat16) if t.is_floating_point() else t)(torch.as_tensor(a)))
    def _A_setup():
        B, Sq, D = 1, 1, 1024
        Hq, Hkv, Sk, Dh = 32, 4, 65536, 128
        assert Hq % Hkv == 0, (Hq, Hkv)
        return {
            "x": _w((lambda *s: torch.randn(*s, dtype=torch.bfloat16) * 0.4)(B, Sq, D)),
            "k_cache": _w((lambda *s: torch.randn(*s, dtype=torch.bfloat16) * 1.6)(B, Hkv, Sk, Dh)),
            "v_cache": _w((lambda *s: torch.randn(*s, dtype=torch.bfloat16) * 1.6)(B, Hkv, Sk, Dh)),
            "wq": _w((lambda *s: torch.randn(*s, dtype=torch.bfloat16) * 1.6)(D, Hq * Dh) * (D ** -0.5)),
            "wo": _w((lambda *s: torch.randn(*s, dtype=torch.bfloat16) * 1.6)(Hq * Dh, D) * ((Hq * Dh) ** -0.5)),
        }
    _A_in = _A_setup()

    def _B_setup():
        B, S, D, F = 1, 1, 1024, 3584
        return {
            "x": _w((lambda *s: torch.randn(*s, dtype=torch.bfloat16) * 0.4)(B, S, D)),
            "w1": _w((lambda *s: torch.randn(*s, dtype=torch.bfloat16) * 1.6)(D, F) * (2.0 / D) ** 0.5),
            "w3": _w((lambda *s: torch.randn(*s, dtype=torch.bfloat16) * 1.6)(D, F) * (2.0 / D) ** 0.5),
            "w2": _w((lambda *s: torch.randn(*s, dtype=torch.bfloat16) * 1.6)(F, D) * (2.0 / F) ** 0.5),
        }
    _B_in = _B_setup()

    return {
        "A_x": _A_in["x"],
        "A_k_cache": _A_in["k_cache"],
        "A_v_cache": _A_in["v_cache"],
        "A_wq": _A_in["wq"],
        "A_wo": _A_in["wo"],
        "B_x": _B_in["x"],
        "B_w1": _B_in["w1"],
        "B_w3": _B_in["w3"],
        "B_w2": _B_in["w2"],
    }

def reference(A_x, A_k_cache, A_v_cache, A_wq, A_wo, B_x, B_w1, B_w3, B_w2):
    def _A_ref(x, k_cache, v_cache, wq, wo):
        B, Sq, D = x.shape
        Hq, Dh = 32, 128
        Hkv = k_cache.shape[1]
        rep = Hq // Hkv
        q = (lambda x, *d: x.permute(*d))((x @ wq).reshape(B, Sq, Hq, Dh), 0, 2, 1, 3)
        k = (lambda x, n, axis: torch.repeat_interleave(x, n, dim=axis))(k_cache, rep, axis=1)
        v = (lambda x, n, axis: torch.repeat_interleave(x, n, dim=axis))(v_cache, rep, axis=1)
        scores = torch.einsum("bhqd,bhkd->bhqk", q, k) * (Dh ** -0.5)
        p = _softmax(scores, axis=-1)
        o = torch.einsum("bhqk,bhkd->bhqd", p, v)
        return (lambda x, *d: x.permute(*d))(o, 0, 2, 1, 3).reshape(B, Sq, Hq * Dh) @ wo

    def _B_ref(x, w1, w3, w2):
        gate = torch.einsum("bsd,df->bsf", x, w1)
        up = torch.einsum("bsd,df->bsf", x, w3)
        h = _silu(gate) * up
        out = torch.einsum("bsf,fd->bsd", h, w2)
        return out

    x = A_x
    xn = _layernorm(x, axis=-1)
    s = _A_ref(xn, A_k_cache, A_v_cache, A_wq, A_wo)
    g = _silu(_B_ref(xn, B_w1, B_w3, B_w2))
    return x + s * g
```

```asm
; @launch grid=(256,1,1) block=(256,1,1) lds=32768
.amdgcn_target "amdgcn-amd-amdhsa--gfx950"
.text
.globl recurrent_scan__gqa_block_cached__glu_gated_swiglu__decode_kernel
.p2align 8
.type recurrent_scan__gqa_block_cached__glu_gated_swiglu__decode_kernel,@function
recurrent_scan__gqa_block_cached__glu_gated_swiglu__decode_kernel:
s_cmp_ge_u32 s2, 256
s_cbranch_scc1 end_10001
s_cmp_ge_u32 s2, 64
s_cbranch_scc1 nopf_10002
v_cmp_gt_u32 vcc, 64, v0
s_nop 1
s_cbranch_vccz nopf_10002
s_getpc_b64 s[48:49]
pfbase_10003:
v_lshlrev_b32 v12, 7, v0
v_min_u32 v13, end_10001-pfbase_10003-4, v12
global_load_dword v236, v13, s[48:49]
v_add_u32 v12, 0x2000, v12
v_min_u32 v13, end_10001-pfbase_10003-4, v12
global_load_dword v237, v13, s[48:49]
v_add_u32 v12, 0x2000, v12
v_min_u32 v13, end_10001-pfbase_10003-4, v12
global_load_dword v238, v13, s[48:49]
v_add_u32 v12, 0x2000, v12
nopf_10002:
s_load_dwordx2 s[4:5], s[0:1], 0
s_load_dwordx2 s[8:9], s[0:1], 8
s_load_dwordx2 s[12:13], s[0:1], 16
s_load_dwordx2 s[16:17], s[0:1], 24
s_load_dwordx2 s[20:21], s[0:1], 32
s_load_dwordx2 s[24:25], s[0:1], 48
s_load_dwordx2 s[28:29], s[0:1], 56
s_load_dwordx2 s[32:33], s[0:1], 64
s_load_dwordx2 s[36:37], s[0:1], 72
s_load_dwordx2 s[40:41], s[0:1], 80
s_load_dwordx2 s[44:45], s[0:1], 88
s_mov_b32 s6, 0x800
s_mov_b32 s7, 0x20000
s_mov_b32 s10, 0x4000000
s_mov_b32 s11, 0x20000
s_mov_b32 s14, 0x4000000
s_mov_b32 s15, 0x20000
s_mov_b32 s18, 0x800000
s_mov_b32 s19, 0x20000
s_mov_b32 s22, 0x800000
s_mov_b32 s23, 0x20000
s_mov_b32 s26, 0x700000
s_mov_b32 s27, 0x20000
s_mov_b32 s30, 0x700000
s_mov_b32 s31, 0x20000
s_mov_b32 s34, 0x700000
s_mov_b32 s35, 0x20000
s_mov_b32 s38, 0x800
s_mov_b32 s39, 0x20000
s_mov_b32 s42, 0x100
s_mov_b32 s43, 0x20000
s_mov_b32 s46, 0x10000000
s_mov_b32 s47, 0x20000
s_cmp_lt_u32 s2, 224
s_cselect_b32 s26, s26, 0
s_cselect_b32 s30, s30, 0
v_lshrrev_b32 v12, 6, v0
v_and_b32 v1, 63, v0
v_readfirstlane_b32 s48, v12
s_lshr_b32 s49, s2, 6
s_and_b32 s50, s2, 63
s_mov_b32 s53, 0x05040100
s_mov_b32 s54, 0x07060302
s_mov_b32 s57, 0xff
s_mov_b32 s58, 0x3fb8aa3b
s_mov_b32 s59, 0x3db504f3
s_mov_b32 s60, 0xffff0000
s_lshr_b32 s66, s2, 1
s_and_b32 s67, s2, 1
v_lshlrev_b32 v3, 4, v1
v_lshlrev_b32 v13, 5, v1
s_lshl_b32 s62, s48, 9
v_lshlrev_b32 v14, 3, v1
v_lshrrev_b32 v15, 3, v1
v_lshlrev_b32 v15, 13, v15
v_and_b32 v16, 7, v1
v_lshlrev_b32 v16, 4, v16
v_add_u32 v15, v15, v16
v_lshrrev_b32 v17, 4, v1
v_mul_u32_u24 v17, 7168, v17
v_and_b32 v18, 15, v1
v_lshlrev_b32 v18, 4, v18
v_add_u32 v17, v17, v18
s_and_b32 s63, s50, 3
s_lshl_b32 s63, s63, 21
s_lshl_b32 s64, s48, 19
s_add_u32 s63, s63, s64
s_lshl_b32 s64, s49, 11
s_add_u32 s63, s63, s64
s_lshr_b32 s64, s50, 2
s_lshl_b32 s64, s64, 7
s_add_u32 s63, s63, s64
s_and_b32 s64, s2, 7
s_lshl_b32 s64, s64, 7
s_lshl_b32 s65, s48, 5
s_add_u32 s64, s64, s65
s_mul_i32 s64, s64, 7168
s_lshr_b32 s69, s2, 3
s_add_u32 s69, s69, 1
s_sub_u32 s65, s69, 28
s_cselect_b32 s69, s69, s65
s_lshr_b32 s70, s2, 3
s_add_u32 s70, s70, 2
s_sub_u32 s65, s70, 28
s_cselect_b32 s70, s70, s65
s_lshl_b32 s65, s70, 8
s_add_u32 s71, s64, s65
s_lshl_b32 s65, s69, 8
s_add_u32 s64, s64, s65
s_waitcnt lgkmcnt(0)
s_load_dword s55, s[44:45], 0
buffer_load_dwordx4 v[224:227], v13, s[4:7], 0 offen
buffer_load_dwordx4 v[228:231], v13, s[4:7], 0 offen offset:16
buffer_load_dwordx2 v[232:233], v14, s[4:7], s62 offen
s_add_u32 s51, s63, 0
buffer_load_dwordx4 v[128:131], v15, s[16:19], s51 offen nt
s_add_u32 s51, s63, 65536
buffer_load_dwordx4 v[132:135], v15, s[16:19], s51 offen nt
s_add_u32 s51, s63, 131072
buffer_load_dwordx4 v[136:139], v15, s[16:19], s51 offen nt
s_add_u32 s51, s63, 196608
buffer_load_dwordx4 v[140:143], v15, s[16:19], s51 offen nt
s_add_u32 s51, s63, 262144
buffer_load_dwordx4 v[144:147], v15, s[16:19], s51 offen nt
s_add_u32 s51, s63, 327680
buffer_load_dwordx4 v[148:151], v15, s[16:19], s51 offen nt
s_add_u32 s51, s63, 393216
buffer_load_dwordx4 v[152:155], v15, s[16:19], s51 offen nt
s_add_u32 s51, s63, 458752
buffer_load_dwordx4 v[156:159], v15, s[16:19], s51 offen nt
s_add_u32 s51, s64, 0
buffer_load_dwordx4 v[160:163], v17, s[24:27], s51 offen nt
s_add_u32 s51, s64, 28672
buffer_load_dwordx4 v[164:167], v17, s[24:27], s51 offen nt
s_add_u32 s51, s64, 57344
buffer_load_dwordx4 v[168:171], v17, s[24:27], s51 offen nt
s_add_u32 s51, s64, 86016
buffer_load_dwordx4 v[172:175], v17, s[24:27], s51 offen nt
s_add_u32 s51, s64, 114688
buffer_load_dwordx4 v[176:179], v17, s[24:27], s51 offen nt
s_add_u32 s51, s64, 143360
buffer_load_dwordx4 v[180:183], v17, s[24:27], s51 offen nt
s_add_u32 s51, s64, 172032
buffer_load_dwordx4 v[184:187], v17, s[24:27], s51 offen nt
s_add_u32 s51, s64, 200704
buffer_load_dwordx4 v[188:191], v17, s[24:27], s51 offen nt
s_lshl_b32 s52, s49, 24
s_lshr_b32 s65, s50, 0
s_lshl_b32 s65, s65, 18
s_add_u32 s52, s52, s65
s_and_b32 s65, s50, 0
s_lshl_b32 s65, s65, 12
s_add_u32 s52, s52, s65
s_lshl_b32 s65, s48, 10
s_add_u32 s52, s52, s65
v_and_b32 v12, 3, v1
v_lshlrev_b32 v12, 12, v12
v_bfe_u32 v2, v1, 2, 1
v_lshlrev_b32 v2, 8, v2
v_add_u32 v2, v2, v12
v_bfe_u32 v12, v1, 3, 1
v_lshlrev_b32 v12, 6, v12
v_add_u32 v2, v2, v12
v_lshrrev_b32 v12, 4, v1
v_lshlrev_b32 v12, 4, v12
v_add_u32 v2, v2, v12
v_and_b32 v12, 1, v1
v_lshlrev_b32 v12, 4, v12
v_mov_b32 v13, 0xffff
v_lshlrev_b32 v13, v12, v13
v_bfe_u32 v12, v1, 1, 2
v_cmp_eq_u32 vcc, 0, v12
s_nop 1
v_cndmask_b32 v4, 0, v13, vcc
v_cmp_eq_u32 vcc, 1, v12
s_nop 1
v_cndmask_b32 v5, 0, v13, vcc
v_cmp_eq_u32 vcc, 2, v12
s_nop 1
v_cndmask_b32 v6, 0, v13, vcc
v_cmp_eq_u32 vcc, 3, v12
s_nop 1
v_cndmask_b32 v7, 0, v13, vcc
s_waitcnt vmcnt(17)
v_lshlrev_b32 v32, 16, v224
v_and_b32 v33, 0xffff0000, v224
v_lshlrev_b32 v34, 16, v225
v_and_b32 v35, 0xffff0000, v225
v_lshlrev_b32 v36, 16, v226
v_and_b32 v37, 0xffff0000, v226
v_lshlrev_b32 v38, 16, v227
v_and_b32 v39, 0xffff0000, v227
v_lshlrev_b32 v40, 16, v228
v_and_b32 v41, 0xffff0000, v228
v_lshlrev_b32 v42, 16, v229
v_and_b32 v43, 0xffff0000, v229
v_lshlrev_b32 v44, 16, v230
v_and_b32 v45, 0xffff0000, v230
v_lshlrev_b32 v46, 16, v231
v_and_b32 v47, 0xffff0000, v231
v_add_f32 v48, v32, v33
v_add_f32 v49, v34, v35
v_add_f32 v50, v36, v37
v_add_f32 v51, v38, v39
v_add_f32 v52, v40, v41
v_add_f32 v53, v42, v43
v_add_f32 v54, v44, v45
v_add_f32 v55, v46, v47
v_add_f32 v48, v48, v49
v_add_f32 v50, v50, v51
v_add_f32 v52, v52, v53
v_add_f32 v54, v54, v55
v_add_f32 v48, v48, v50
v_add_f32 v52, v52, v54
v_add_f32 v48, v48, v52
s_nop 1
v_add_f32_dpp v48, v48, v48 row_ror:8 row_mask:0xf bank_mask:0xf
s_nop 1
v_add_f32_dpp v48, v48, v48 row_ror:4 row_mask:0xf bank_mask:0xf
s_nop 1
v_add_f32_dpp v48, v48, v48 row_ror:2 row_mask:0xf bank_mask:0xf
s_nop 1
v_add_f32_dpp v48, v48, v48 row_ror:1 row_mask:0xf bank_mask:0xf
v_mov_b32 v49, v48
s_nop 1
v_permlane16_swap_b32 v48, v49
v_add_f32 v48, v48, v49
v_mov_b32 v49, v48
s_nop 1
v_permlane32_swap_b32 v48, v49
v_add_f32 v48, v48, v49
v_mul_f32 v49, 0x3a800000, v48
v_sub_f32 v32, v32, v49
v_sub_f32 v33, v33, v49
v_sub_f32 v34, v34, v49
v_sub_f32 v35, v35, v49
v_sub_f32 v36, v36, v49
v_sub_f32 v37, v37, v49
v_sub_f32 v38, v38, v49
v_sub_f32 v39, v39, v49
v_sub_f32 v40, v40, v49
v_sub_f32 v41, v41, v49
v_sub_f32 v42, v42, v49
v_sub_f32 v43, v43, v49
v_sub_f32 v44, v44, v49
v_sub_f32 v45, v45, v49
v_sub_f32 v46, v46, v49
v_sub_f32 v47, v47, v49
v_mul_f32 v50, v32, v32
v_mul_f32 v51, v33, v33
v_mul_f32 v52, v34, v34
v_mul_f32 v53, v35, v35
v_fmac_f32 v50, v36, v36
v_fmac_f32 v51, v37, v37
v_fmac_f32 v52, v38, v38
v_fmac_f32 v53, v39, v39
v_fmac_f32 v50, v40, v40
v_fmac_f32 v51, v41, v41
v_fmac_f32 v52, v42, v42
v_fmac_f32 v53, v43, v43
v_fmac_f32 v50, v44, v44
v_fmac_f32 v51, v45, v45
v_fmac_f32 v52, v46, v46
v_fmac_f32 v53, v47, v47
v_add_f32 v50, v50, v51
v_add_f32 v52, v52, v53
v_add_f32 v50, v50, v52
s_nop 1
v_add_f32_dpp v50, v50, v50 row_ror:8 row_mask:0xf bank_mask:0xf
s_nop 1
v_add_f32_dpp v50, v50, v50 row_ror:4 row_mask:0xf bank_mask:0xf
s_nop 1
v_add_f32_dpp v50, v50, v50 row_ror:2 row_mask:0xf bank_mask:0xf
s_nop 1
v_add_f32_dpp v50, v50, v50 row_ror:1 row_mask:0xf bank_mask:0xf
v_mov_b32 v51, v50
s_nop 1
v_permlane16_swap_b32 v50, v51
v_add_f32 v50, v50, v51
v_mov_b32 v51, v50
s_nop 1
v_permlane32_swap_b32 v50, v51
v_add_f32 v50, v50, v51
v_mul_f32 v50, 0x3a800000, v50
v_cvt_pk_bf16_f32 v51, v49, v50
v_lshlrev_b32 v52, 16, v51
v_and_b32 v53, 0xffff0000, v51
v_add_f32 v53, 0x3727c5ac, v53
v_cvt_pk_bf16_f32 v53, v53, v53
v_lshlrev_b32 v53, 16, v53
v_sqrt_f32 v53, v53
s_nop 0
v_cvt_pk_bf16_f32 v53, v53, v53
v_lshlrev_b32 v53, 16, v53
v_rcp_f32 v54, v53
s_waitcnt vmcnt(16)
v_lshlrev_b32 v32, 16, v232
v_and_b32 v33, 0xffff0000, v232
v_lshlrev_b32 v34, 16, v233
v_and_b32 v35, 0xffff0000, v233
v_sub_f32 v32, v32, v52
v_sub_f32 v33, v33, v52
v_sub_f32 v34, v34, v52
v_sub_f32 v35, v35, v52
v_cvt_pk_bf16_f32 v36, v32, v33
v_cvt_pk_bf16_f32 v37, v34, v35
v_lshlrev_b32 v32, 16, v36
v_and_b32 v33, 0xffff0000, v36
v_lshlrev_b32 v34, 16, v37
v_and_b32 v35, 0xffff0000, v37
v_mul_f32 v40, v32, v54
v_mul_f32 v41, v33, v54
v_mul_f32 v42, v34, v54
v_mul_f32 v43, v35, v54
v_fma_f32 v44, -v40, v53, v32
v_fma_f32 v45, -v41, v53, v33
v_fma_f32 v46, -v42, v53, v34
v_fma_f32 v47, -v43, v53, v35
v_fma_f32 v40, v44, v54, v40
v_fma_f32 v41, v45, v54, v41
v_fma_f32 v42, v46, v54, v42
v_fma_f32 v43, v47, v54, v43
v_cvt_pk_bf16_f32 v36, v40, v40
v_cvt_pk_bf16_f32 v37, v41, v41
v_cvt_pk_bf16_f32 v38, v42, v42
v_cvt_pk_bf16_f32 v39, v43, v43
v_lshlrev_b32 v12, 4, v0
ds_write_b128 v12, v[36:39] offset:0
s_waitcnt lgkmcnt(0)
s_barrier
s_add_u32 s55, s55, 1
s_and_b32 s56, s55, 0xff
v_mov_b32 v8, s56
s_and_b32 s62, s50, 3
s_lshl_b32 s62, s62, 8
s_lshl_b32 s65, s48, 6
s_add_u32 s62, s62, s65
v_lshrrev_b32 v12, 3, v1
v_add_u32 v12, s62, v12
v_lshlrev_b32 v12, 2, v12
s_and_b32 s62, s2, 7
s_lshl_b32 s62, s62, 7
s_lshl_b32 s65, s48, 5
s_add_u32 s62, s62, s65
v_lshrrev_b32 v13, 4, v1
v_add_u32 v13, s62, v13
v_lshlrev_b32 v13, 2, v13
ds_read2_b32 v[96:97], v12 offset0:0 offset1:8
ds_read2_b32 v[98:99], v12 offset0:16 offset1:24
ds_read2_b32 v[100:101], v12 offset0:32 offset1:40
ds_read2_b32 v[102:103], v12 offset0:48 offset1:56
ds_read2_b32 v[104:105], v13 offset0:0 offset1:4
ds_read2_b32 v[106:107], v13 offset0:8 offset1:12
ds_read2_b32 v[108:109], v13 offset0:16 offset1:20
ds_read2_b32 v[110:111], v13 offset0:24 offset1:28
s_add_u32 s51, s71, 0
buffer_load_dwordx4 v[192:195], v17, s[28:31], s51 offen nt
s_add_u32 s51, s71, 28672
buffer_load_dwordx4 v[196:199], v17, s[28:31], s51 offen nt
s_add_u32 s51, s71, 57344
buffer_load_dwordx4 v[200:203], v17, s[28:31], s51 offen nt
s_add_u32 s51, s71, 86016
buffer_load_dwordx4 v[204:207], v17, s[28:31], s51 offen nt
s_add_u32 s51, s71, 114688
buffer_load_dwordx4 v[208:211], v17, s[28:31], s51 offen nt
s_add_u32 s51, s71, 143360
buffer_load_dwordx4 v[212:215], v17, s[28:31], s51 offen nt
s_add_u32 s51, s71, 172032
buffer_load_dwordx4 v[216:219], v17, s[28:31], s51 offen nt
s_add_u32 s51, s71, 200704
buffer_load_dwordx4 v[220:223], v17, s[28:31], s51 offen nt
s_waitcnt lgkmcnt(0)
v_and_b32 v48, v96, v4
v_and_b32 v49, v96, v5
v_and_b32 v50, v96, v6
v_and_b32 v51, v96, v7
s_waitcnt vmcnt(16)
s_nop 0
v_mfma_f32_16x16x32_bf16 v[56:59], v[48:51], v[128:131], 0
v_and_b32 v52, v97, v4
v_and_b32 v53, v97, v5
v_and_b32 v54, v97, v6
v_and_b32 v55, v97, v7
s_nop 1
v_mfma_f32_16x16x32_bf16 v[56:59], v[52:55], v[132:135], v[56:59]
v_and_b32 v48, v98, v4
v_and_b32 v49, v98, v5
v_and_b32 v50, v98, v6
v_and_b32 v51, v98, v7
s_nop 1
v_mfma_f32_16x16x32_bf16 v[56:59], v[48:51], v[136:139], v[56:59]
v_and_b32 v52, v99, v4
v_and_b32 v53, v99, v5
v_and_b32 v54, v99, v6
v_and_b32 v55, v99, v7
s_nop 1
v_mfma_f32_16x16x32_bf16 v[56:59], v[52:55], v[140:143], v[56:59]
v_and_b32 v48, v100, v4
v_and_b32 v49, v100, v5
v_and_b32 v50, v100, v6
v_and_b32 v51, v100, v7
s_nop 1
v_mfma_f32_16x16x32_bf16 v[56:59], v[48:51], v[144:147], v[56:59]
v_and_b32 v52, v101, v4
v_and_b32 v53, v101, v5
v_and_b32 v54, v101, v6
v_and_b32 v55, v101, v7
s_nop 1
v_mfma_f32_16x16x32_bf16 v[56:59], v[52:55], v[148:151], v[56:59]
v_and_b32 v48, v102, v4
v_and_b32 v49, v102, v5
v_and_b32 v50, v102, v6
v_and_b32 v51, v102, v7
s_nop 1
v_mfma_f32_16x16x32_bf16 v[56:59], v[48:51], v[152:155], v[56:59]
v_and_b32 v52, v103, v4
v_and_b32 v53, v103, v5
v_and_b32 v54, v103, v6
v_and_b32 v55, v103, v7
s_nop 1
v_mfma_f32_16x16x32_bf16 v[56:59], v[52:55], v[156:159], v[56:59]
v_and_b32 v64, v104, v4
v_and_b32 v65, v104, v5
v_and_b32 v66, v104, v6
v_and_b32 v67, v104, v7
v_and_b32 v68, v105, v4
v_and_b32 v69, v105, v5
v_and_b32 v70, v105, v6
v_and_b32 v71, v105, v7
v_and_b32 v72, v106, v4
v_and_b32 v73, v106, v5
v_and_b32 v74, v106, v6
v_and_b32 v75, v106, v7
v_and_b32 v76, v107, v4
v_and_b32 v77, v107, v5
v_and_b32 v78, v107, v6
v_and_b32 v79, v107, v7
v_and_b32 v80, v108, v4
v_and_b32 v81, v108, v5
v_and_b32 v82, v108, v6
v_and_b32 v83, v108, v7
v_and_b32 v84, v109, v4
v_and_b32 v85, v109, v5
v_and_b32 v86, v109, v6
v_and_b32 v87, v109, v7
v_and_b32 v88, v110, v4
v_and_b32 v89, v110, v5
v_and_b32 v90, v110, v6
v_and_b32 v91, v110, v7
v_and_b32 v92, v111, v4
v_and_b32 v93, v111, v5
v_and_b32 v94, v111, v6
v_and_b32 v95, v111, v7
v_and_b32 v12, 7, v1
v_lshlrev_b32 v12, 5, v12
v_bfe_u32 v13, v1, 4, 1
v_lshlrev_b32 v13, 4, v13
v_add_u32 v12, v12, v13
v_lshrrev_b32 v13, 5, v1
v_lshlrev_b32 v13, 8, v13
v_add_u32 v12, v12, v13
s_lshl_b32 s62, s48, 9
v_add_u32 v12, s62, v12
s_mov_b32 exec_lo, 0x00ff00ff
s_mov_b32 exec_hi, 0xff00ff00
ds_write_b128 v12, v[56:59] offset:4096
s_mov_b64 exec, -1
s_waitcnt lgkmcnt(0)
s_barrier
s_cmp_lg_u32 s48, 0
s_cbranch_scc1 pubq_10004
v_lshlrev_b32 v12, 4, v1
ds_read_b128 v[32:35], v12 offset:4096
ds_read_b128 v[36:39], v12 offset:4352
ds_read_b128 v[40:43], v12 offset:4608
ds_read_b128 v[44:47], v12 offset:4864
ds_read_b128 v[112:115], v12 offset:5120
ds_read_b128 v[116:119], v12 offset:5376
ds_read_b128 v[120:123], v12 offset:5632
ds_read_b128 v[124:127], v12 offset:5888
s_lshl_b32 s63, s49, 2
s_and_b32 s65, s50, 3
s_add_u32 s63, s63, s65
s_lshl_b32 s63, s63, 12
s_lshr_b32 s65, s50, 2
s_lshl_b32 s65, s65, 8
s_add_u32 s63, s63, s65
s_add_u32 s63, s63, 4096
s_waitcnt lgkmcnt(0)
v_add_f32 v32, v32, v36
v_add_f32 v40, v40, v44
v_add_f32 v112, v112, v116
v_add_f32 v120, v120, v124
v_add_f32 v33, v33, v37
v_add_f32 v41, v41, v45
v_add_f32 v113, v113, v117
v_add_f32 v121, v121, v125
v_add_f32 v34, v34, v38
v_add_f32 v42, v42, v46
v_add_f32 v114, v114, v118
v_add_f32 v122, v122, v126
v_add_f32 v35, v35, v39
v_add_f32 v43, v43, v47
v_add_f32 v115, v115, v119
v_add_f32 v123, v123, v127
v_add_f32 v32, v32, v40
v_add_f32 v112, v112, v120
v_add_f32 v33, v33, v41
v_add_f32 v113, v113, v121
v_add_f32 v34, v34, v42
v_add_f32 v114, v114, v122
v_add_f32 v35, v35, v43
v_add_f32 v115, v115, v123
v_add_f32 v32, v32, v112
v_add_f32 v33, v33, v113
v_add_f32 v34, v34, v114
v_add_f32 v35, v35, v115
s_cmp_lg_u32 s50, 0
s_cbranch_scc1 nozero_10005
v_mov_b32 v36, 0
v_mov_b32 v37, 0
v_mov_b32 v38, 0
v_mov_b32 v39, 0
s_lshl_b32 s65, s49, 9
s_add_u32 s65, s65, 114688
s_mov_b32 exec_hi, 0
buffer_store_dwordx4 v[36:39], v12, s[44:47], s65 offen sc1
s_mov_b64 exec, -1
nozero_10005:
s_mov_b32 exec_lo, 0xffff
s_mov_b32 exec_hi, 0
buffer_store_dwordx4 v[32:35], v12, s[44:47], s63 offen sc1
s_mov_b64 exec, -1
pubq_10004:
s_add_u32 s68, s52, 0
buffer_load_dwordx4 a[0:3], v2, s[8:11], s68 offen offset:0 nt
buffer_load_dwordx4 a[4:7], v2, s[8:11], s68 offen offset:128 nt
buffer_load_dwordx4 a[8:11], v2, s[8:11], s68 offen offset:512 nt
buffer_load_dwordx4 a[12:15], v2, s[8:11], s68 offen offset:640 nt
s_add_u32 s68, s68, 16384
buffer_load_dwordx4 a[16:19], v2, s[8:11], s68 offen offset:0 nt
buffer_load_dwordx4 a[20:23], v2, s[8:11], s68 offen offset:128 nt
buffer_load_dwordx4 a[24:27], v2, s[8:11], s68 offen offset:512 nt
buffer_load_dwordx4 a[28:31], v2, s[8:11], s68 offen offset:640 nt
s_waitcnt vmcnt(16)
v_mfma_f32_16x16x32_bf16 v[60:63], v[64:67], v[160:163], 0
v_mfma_f32_16x16x32_bf16 v[60:63], v[68:71], v[164:167], v[60:63]
v_mfma_f32_16x16x32_bf16 v[60:63], v[72:75], v[168:171], v[60:63]
v_mfma_f32_16x16x32_bf16 v[60:63], v[76:79], v[172:175], v[60:63]
v_mfma_f32_16x16x32_bf16 v[60:63], v[80:83], v[176:179], v[60:63]
v_mfma_f32_16x16x32_bf16 v[60:63], v[84:87], v[180:183], v[60:63]
v_mfma_f32_16x16x32_bf16 v[60:63], v[88:91], v[184:187], v[60:63]
v_mfma_f32_16x16x32_bf16 v[60:63], v[92:95], v[188:191], v[60:63]
s_add_u32 s68, s52, 32768
buffer_load_dwordx4 a[32:35], v2, s[8:11], s68 offen offset:0 nt
buffer_load_dwordx4 a[36:39], v2, s[8:11], s68 offen offset:128 nt
buffer_load_dwordx4 a[40:43], v2, s[8:11], s68 offen offset:512 nt
buffer_load_dwordx4 a[44:47], v2, s[8:11], s68 offen offset:640 nt
s_add_u32 s68, s68, 16384
buffer_load_dwordx4 a[48:51], v2, s[8:11], s68 offen offset:0 nt
buffer_load_dwordx4 a[52:55], v2, s[8:11], s68 offen offset:128 nt
buffer_load_dwordx4 a[56:59], v2, s[8:11], s68 offen offset:512 nt
buffer_load_dwordx4 a[60:63], v2, s[8:11], s68 offen offset:640 nt
s_waitcnt vmcnt(16)
v_mfma_f32_16x16x32_bf16 v[96:99], v[64:67], v[192:195], 0
v_mfma_f32_16x16x32_bf16 v[96:99], v[68:71], v[196:199], v[96:99]
v_mfma_f32_16x16x32_bf16 v[96:99], v[72:75], v[200:203], v[96:99]
v_mfma_f32_16x16x32_bf16 v[96:99], v[76:79], v[204:207], v[96:99]
v_mfma_f32_16x16x32_bf16 v[96:99], v[80:83], v[208:211], v[96:99]
v_mfma_f32_16x16x32_bf16 v[96:99], v[84:87], v[212:215], v[96:99]
v_mfma_f32_16x16x32_bf16 v[96:99], v[88:91], v[216:219], v[96:99]
v_mfma_f32_16x16x32_bf16 v[96:99], v[92:95], v[220:223], v[96:99]
s_cmp_lg_u32 s48, 0
s_cbranch_scc1 flag_10006
v_lshlrev_b32 v12, 2, v1
v_mov_b32 v13, s55
s_lshl_b32 s62, s2, 7
s_add_u32 s62, s62, 81920
s_waitcnt vmcnt(16)
s_mov_b32 exec_hi, 0
buffer_store_dword v13, v12, s[44:47], s62 offen sc1
s_mov_b64 exec, -1
flag_10006:
v_and_b32 v12, 15, v1
v_lshlrev_b32 v12, 5, v12
v_bfe_u32 v13, v1, 4, 1
v_lshlrev_b32 v13, 4, v13
v_add_u32 v12, v12, v13
s_lshl_b32 s62, s48, 10
v_add_u32 v12, s62, v12
s_mov_b32 exec_hi, 0
ds_write_b128 v12, v[60:63] offset:6144
ds_write_b128 v12, v[96:99] offset:6656
s_mov_b64 exec, -1
s_add_u32 s68, s52, 65536
buffer_load_dwordx4 a[64:67], v2, s[8:11], s68 offen offset:0 nt
buffer_load_dwordx4 a[68:71], v2, s[8:11], s68 offen offset:128 nt
buffer_load_dwordx4 a[72:75], v2, s[8:11], s68 offen offset:512 nt
buffer_load_dwordx4 a[76:79], v2, s[8:11], s68 offen offset:640 nt
s_add_u32 s68, s68, 16384
buffer_load_dwordx4 a[80:83], v2, s[8:11], s68 offen offset:0 nt
buffer_load_dwordx4 a[84:87], v2, s[8:11], s68 offen offset:128 nt
buffer_load_dwordx4 a[88:91], v2, s[8:11], s68 offen offset:512 nt
buffer_load_dwordx4 a[92:95], v2, s[8:11], s68 offen offset:640 nt
s_waitcnt lgkmcnt(0)
s_barrier
s_cmp_lg_u32 s48, 1
s_cbranch_scc1 pub1_10007
s_cmp_ge_u32 s2, 224
s_cbranch_scc1 pub1_10007
v_lshlrev_b32 v12, 4, v1
ds_read_b128 v[32:35], v12 offset:6144
ds_read_b128 v[36:39], v12 offset:7168
ds_read_b128 v[40:43], v12 offset:8192
ds_read_b128 v[44:47], v12 offset:9216
s_and_b32 s62, s2, 7
s_mul_i32 s62, s62, 14336
s_add_u32 s62, s62, 131072
s_lshl_b32 s65, s69, 9
s_lshl_b32 s63, s70, 9
s_add_u32 s63, s63, 114688
v_mov_b32 v13, s65
v_mov_b32 v14, s63
v_cmp_gt_u32 vcc, 32, v1
s_nop 1
v_cndmask_b32 v13, v14, v13, vcc
v_and_b32 v14, 31, v1
v_lshlrev_b32 v14, 4, v14
v_add_u32 v13, v13, v14
s_waitcnt lgkmcnt(0)
v_add_f32 v32, v32, v36
v_add_f32 v40, v40, v44
v_add_f32 v33, v33, v37
v_add_f32 v41, v41, v45
v_add_f32 v34, v34, v38
v_add_f32 v42, v42, v46
v_add_f32 v35, v35, v39
v_add_f32 v43, v43, v47
v_add_f32 v32, v32, v40
v_add_f32 v33, v33, v41
v_add_f32 v34, v34, v42
v_add_f32 v35, v35, v43
v_bfi_b32 v32, s57, v8, v32
v_bfi_b32 v33, s57, v8, v33
v_bfi_b32 v34, s57, v8, v34
v_bfi_b32 v35, s57, v8, v35
buffer_store_dwordx4 v[32:35], v13, s[44:47], s62 offen sc1
pub1_10007:
s_add_u32 s68, s52, 98304
buffer_load_dwordx4 a[96:99], v2, s[8:11], s68 offen offset:0 nt
buffer_load_dwordx4 a[100:103], v2, s[8:11], s68 offen offset:128 nt
buffer_load_dwordx4 a[104:107], v2, s[8:11], s68 offen offset:512 nt
buffer_load_dwordx4 a[108:111], v2, s[8:11], s68 offen offset:640 nt
s_add_u32 s68, s68, 16384
buffer_load_dwordx4 a[112:115], v2, s[8:11], s68 offen offset:0 nt
buffer_load_dwordx4 a[116:119], v2, s[8:11], s68 offen offset:128 nt
buffer_load_dwordx4 a[120:123], v2, s[8:11], s68 offen offset:512 nt
buffer_load_dwordx4 a[124:127], v2, s[8:11], s68 offen offset:640 nt
s_add_u32 s68, s52, 131072
buffer_load_dwordx4 a[128:131], v2, s[8:11], s68 offen offset:0 nt
buffer_load_dwordx4 a[132:135], v2, s[8:11], s68 offen offset:128 nt
buffer_load_dwordx4 a[136:139], v2, s[8:11], s68 offen offset:512 nt
buffer_load_dwordx4 a[140:143], v2, s[8:11], s68 offen offset:640 nt
s_add_u32 s68, s68, 16384
buffer_load_dwordx4 a[144:147], v2, s[8:11], s68 offen offset:0 nt
buffer_load_dwordx4 a[148:151], v2, s[8:11], s68 offen offset:128 nt
buffer_load_dwordx4 a[152:155], v2, s[8:11], s68 offen offset:512 nt
buffer_load_dwordx4 a[156:159], v2, s[8:11], s68 offen offset:640 nt
v_lshlrev_b32 v14, 7, v1
s_lshl_b32 s63, s49, 13
s_add_u32 s63, s63, 81920
s_cmp_lg_u32 s48, 0
s_cbranch_scc1 nopoll_10008
buffer_load_dword v15, v14, s[44:47], s63 offen sc1
nopoll_10008:
s_add_u32 s68, s52, 163840
buffer_load_dwordx4 a[160:163], v2, s[8:11], s68 offen offset:0 nt
buffer_load_dwordx4 a[164:167], v2, s[8:11], s68 offen offset:128 nt
buffer_load_dwordx4 a[168:171], v2, s[8:11], s68 offen offset:512 nt
buffer_load_dwordx4 a[172:175], v2, s[8:11], s68 offen offset:640 nt
s_add_u32 s68, s68, 16384
buffer_load_dwordx4 a[176:179], v2, s[8:11], s68 offen offset:0 nt
buffer_load_dwordx4 a[180:183], v2, s[8:11], s68 offen offset:128 nt
buffer_load_dwordx4 a[184:187], v2, s[8:11], s68 offen offset:512 nt
buffer_load_dwordx4 a[188:191], v2, s[8:11], s68 offen offset:640 nt
s_add_u32 s68, s52, 196608
buffer_load_dwordx4 a[192:195], v2, s[8:11], s68 offen offset:0 nt
buffer_load_dwordx4 a[196:199], v2, s[8:11], s68 offen offset:128 nt
s_cmp_lg_u32 s48, 0
s_cbranch_scc1 okpoll_10009
s_waitcnt vmcnt(10)
s_mov_b32 s61, 40000
rpoll_10010:
v_cmp_ne_u32 vcc, s55, v15
s_nop 1
s_cbranch_vccz okpoll_10009
s_sub_u32 s61, s61, 1
s_cbranch_scc1 okpoll_10009
s_sleep 8
buffer_load_dword v15, v14, s[44:47], s63 offen sc1
s_waitcnt vmcnt(0)
s_branch rpoll_10010
okpoll_10009:
s_barrier
s_lshl_b32 s62, s49, 14
s_lshl_b32 s65, s48, 10
s_add_u32 s62, s62, s65
s_add_u32 s62, s62, 4096
s_add_u32 s51, s62, 0
buffer_load_dwordx4 v[96:99], v3, s[44:47], s51 offen sc1
s_add_u32 s51, s62, 4096
buffer_load_dwordx4 v[100:103], v3, s[44:47], s51 offen sc1
s_add_u32 s51, s62, 8192
buffer_load_dwordx4 v[104:107], v3, s[44:47], s51 offen sc1
s_add_u32 s51, s62, 12288
buffer_load_dwordx4 v[108:111], v3, s[44:47], s51 offen sc1
buffer_load_dwordx4 a[200:203], v2, s[8:11], s68 offen offset:512 nt
buffer_load_dwordx4 a[204:207], v2, s[8:11], s68 offen offset:640 nt
s_add_u32 s68, s68, 16384
buffer_load_dwordx4 a[208:211], v2, s[8:11], s68 offen offset:0 nt
buffer_load_dwordx4 a[212:215], v2, s[8:11], s68 offen offset:128 nt
buffer_load_dwordx4 a[216:219], v2, s[8:11], s68 offen offset:512 nt
buffer_load_dwordx4 a[220:223], v2, s[8:11], s68 offen offset:640 nt
s_add_u32 s68, s52, 229376
buffer_load_dwordx4 a[224:227], v2, s[8:11], s68 offen offset:0 nt
buffer_load_dwordx4 a[228:231], v2, s[8:11], s68 offen offset:128 nt
buffer_load_dwordx4 a[232:235], v2, s[8:11], s68 offen offset:512 nt
buffer_load_dwordx4 a[236:239], v2, s[8:11], s68 offen offset:640 nt
v_lshrrev_b32 v12, 5, v1
s_lshl_b32 s62, s48, 1
v_add_u32 v12, s62, v12
v_mul_u32_u24 v12, 272, v12
v_and_b32 v13, 31, v1
v_lshlrev_b32 v13, 3, v13
v_add_u32 v12, v12, v13
v_and_b32 v14, 7, v1
v_mul_u32_u24 v14, 272, v14
v_lshrrev_b32 v13, 4, v1
v_lshlrev_b32 v13, 4, v13
v_add_u32 v14, v14, v13
v_bfe_u32 v13, v1, 3, 1
v_lshlrev_b32 v13, 6, v13
v_add_u32 v14, v14, v13
v_mov_b32 v9, 0xff800000
s_waitcnt vmcnt(10)
v_add_f32 v96, v96, v100
v_add_f32 v104, v104, v108
v_add_f32 v97, v97, v101
v_add_f32 v105, v105, v109
v_add_f32 v98, v98, v102
v_add_f32 v106, v106, v110
v_add_f32 v99, v99, v103
v_add_f32 v107, v107, v111
v_add_f32 v96, v96, v104
v_add_f32 v97, v97, v105
v_add_f32 v98, v98, v106
v_add_f32 v99, v99, v107
v_cvt_pk_bf16_f32 v96, v96, v97
v_cvt_pk_bf16_f32 v97, v98, v99
ds_write_b64 v12, v[96:97] offset:10240
s_waitcnt lgkmcnt(0)
s_barrier
ds_read_b128 v[16:19], v14 offset:10240
ds_read_b128 v[20:23], v14 offset:10368
s_add_u32 s68, s68, 16384
buffer_load_dwordx4 a[240:243], v2, s[8:11], s68 offen offset:0 nt
s_waitcnt lgkmcnt(0)
s_waitcnt vmcnt(57)
v_mfma_f32_16x16x32_bf16 v[64:67], a[0:3], v[16:19], 0
v_mfma_f32_16x16x32_bf16 v[68:71], a[8:11], v[16:19], 0
v_mfma_f32_16x16x32_bf16 v[72:75], a[16:19], v[16:19], 0
v_mfma_f32_16x16x32_bf16 v[76:79], a[24:27], v[16:19], 0
v_mfma_f32_16x16x32_bf16 v[64:67], a[4:7], v[20:23], v[64:67]
v_mfma_f32_16x16x32_bf16 v[68:71], a[12:15], v[20:23], v[68:71]
v_mfma_f32_16x16x32_bf16 v[72:75], a[20:23], v[20:23], v[72:75]
v_mfma_f32_16x16x32_bf16 v[76:79], a[28:31], v[20:23], v[76:79]
s_waitcnt vmcnt(49)
v_mfma_f32_16x16x32_bf16 v[80:83], a[32:35], v[16:19], 0
v_mfma_f32_16x16x32_bf16 v[84:87], a[40:43], v[16:19], 0
v_mfma_f32_16x16x32_bf16 v[88:91], a[48:51], v[16:19], 0
v_mfma_f32_16x16x32_bf16 v[92:95], a[56:59], v[16:19], 0
v_mfma_f32_16x16x32_bf16 v[80:83], a[36:39], v[20:23], v[80:83]
v_mfma_f32_16x16x32_bf16 v[84:87], a[44:47], v[20:23], v[84:87]
v_mfma_f32_16x16x32_bf16 v[88:91], a[52:55], v[20:23], v[88:91]
v_mfma_f32_16x16x32_bf16 v[92:95], a[60:63], v[20:23], v[92:95]
v_permlane32_swap_b32 v64, v68
v_permlane32_swap_b32 v65, v69
v_permlane32_swap_b32 v66, v70
v_permlane32_swap_b32 v67, v71
v_permlane32_swap_b32 v72, v76
v_permlane32_swap_b32 v73, v77
v_permlane32_swap_b32 v74, v78
v_permlane32_swap_b32 v75, v79
v_add_f32_dpp v64, v68, v64 row_ror:8 row_mask:0xf bank_mask:0xf
v_add_f32_dpp v65, v69, v65 row_ror:8 row_mask:0xf bank_mask:0xf
v_add_f32_dpp v66, v70, v66 row_ror:8 row_mask:0xf bank_mask:0xf
v_add_f32_dpp v67, v71, v67 row_ror:8 row_mask:0xf bank_mask:0xf
v_add_f32_dpp v72, v76, v72 row_ror:8 row_mask:0xf bank_mask:0xf
v_add_f32_dpp v73, v77, v73 row_ror:8 row_mask:0xf bank_mask:0xf
v_add_f32_dpp v74, v78, v74 row_ror:8 row_mask:0xf bank_mask:0xf
v_add_f32_dpp v75, v79, v75 row_ror:8 row_mask:0xf bank_mask:0xf
buffer_load_dwordx4 a[244:247], v2, s[8:11], s68 offen offset:128 nt
v_cvt_pk_bf16_f32 v68, v64, v65
v_cvt_pk_bf16_f32 v69, v66, v67
v_cvt_pk_bf16_f32 v70, v72, v73
v_cvt_pk_bf16_f32 v71, v74, v75
v_lshlrev_b32 v24, 16, v68
v_and_b32 v25, 0xffff0000, v68
v_lshlrev_b32 v26, 16, v69
v_and_b32 v27, 0xffff0000, v69
v_lshlrev_b32 v28, 16, v70
v_and_b32 v29, 0xffff0000, v70
v_lshlrev_b32 v30, 16, v71
v_and_b32 v31, 0xffff0000, v71
v_mul_f32 v24, s59, v24
v_mul_f32 v25, s59, v25
v_mul_f32 v26, s59, v26
v_mul_f32 v27, s59, v27
v_mul_f32 v28, s59, v28
v_mul_f32 v29, s59, v29
v_mul_f32 v30, s59, v30
v_mul_f32 v31, s59, v31
buffer_load_dwordx4 a[248:251], v2, s[8:11], s68 offen offset:512 nt
v_cvt_pk_bf16_f32 v32, v24, v25
v_max3_f32 v9, v9, v24, v25
v_cvt_pk_bf16_f32 v33, v26, v27
v_max3_f32 v9, v9, v26, v27
v_cvt_pk_bf16_f32 v34, v28, v29
v_max3_f32 v9, v9, v28, v29
v_cvt_pk_bf16_f32 v35, v30, v31
v_max3_f32 v9, v9, v30, v31
s_waitcnt vmcnt(43)
v_mfma_f32_16x16x32_bf16 v[64:67], a[64:67], v[16:19], 0
v_mfma_f32_16x16x32_bf16 v[68:71], a[72:75], v[16:19], 0
v_mfma_f32_16x16x32_bf16 v[72:75], a[80:83], v[16:19], 0
v_mfma_f32_16x16x32_bf16 v[76:79], a[88:91], v[16:19], 0
v_mfma_f32_16x16x32_bf16 v[64:67], a[68:71], v[20:23], v[64:67]
v_mfma_f32_16x16x32_bf16 v[68:71], a[76:79], v[20:23], v[68:71]
v_mfma_f32_16x16x32_bf16 v[72:75], a[84:87], v[20:23], v[72:75]
v_mfma_f32_16x16x32_bf16 v[76:79], a[92:95], v[20:23], v[76:79]
v_permlane32_swap_b32 v80, v84
v_permlane32_swap_b32 v81, v85
v_permlane32_swap_b32 v82, v86
v_permlane32_swap_b32 v83, v87
v_permlane32_swap_b32 v88, v92
v_permlane32_swap_b32 v89, v93
v_permlane32_swap_b32 v90, v94
v_permlane32_swap_b32 v91, v95
v_add_f32_dpp v80, v84, v80 row_ror:8 row_mask:0xf bank_mask:0xf
v_add_f32_dpp v81, v85, v81 row_ror:8 row_mask:0xf bank_mask:0xf
v_add_f32_dpp v82, v86, v82 row_ror:8 row_mask:0xf bank_mask:0xf
v_add_f32_dpp v83, v87, v83 row_ror:8 row_mask:0xf bank_mask:0xf
v_add_f32_dpp v88, v92, v88 row_ror:8 row_mask:0xf bank_mask:0xf
v_add_f32_dpp v89, v93, v89 row_ror:8 row_mask:0xf bank_mask:0xf
v_add_f32_dpp v90, v94, v90 row_ror:8 row_mask:0xf bank_mask:0xf
v_add_f32_dpp v91, v95, v91 row_ror:8 row_mask:0xf bank_mask:0xf
buffer_load_dwordx4 a[252:255], v2, s[8:11], s68 offen offset:640 nt
v_cvt_pk_bf16_f32 v84, v80, v81
v_cvt_pk_bf16_f32 v85, v82, v83
v_cvt_pk_bf16_f32 v86, v88, v89
v_cvt_pk_bf16_f32 v87, v90, v91
v_lshlrev_b32 v24, 16, v84
v_and_b32 v25, 0xffff0000, v84
v_lshlrev_b32 v26, 16, v85
v_and_b32 v27, 0xffff0000, v85
v_lshlrev_b32 v28, 16, v86
v_and_b32 v29, 0xffff0000, v86
v_lshlrev_b32 v30, 16, v87
v_and_b32 v31, 0xffff0000, v87
v_mul_f32 v24, s59, v24
v_mul_f32 v25, s59, v25
v_mul_f32 v26, s59, v26
v_mul_f32 v27, s59, v27
v_mul_f32 v28, s59, v28
v_mul_f32 v29, s59, v29
v_mul_f32 v30, s59, v30
v_mul_f32 v31, s59, v31
s_add_u32 s72, s52, 0
buffer_load_dwordx4 v[128:131], v3, s[12:15], s72 offen nt
v_cvt_pk_bf16_f32 v36, v24, v25
v_max3_f32 v9, v9, v24, v25
v_cvt_pk_bf16_f32 v37, v26, v27
v_max3_f32 v9, v9, v26, v27
v_cvt_pk_bf16_f32 v38, v28, v29
v_max3_f32 v9, v9, v28, v29
v_cvt_pk_bf16_f32 v39, v30, v31
v_max3_f32 v9, v9, v30, v31
s_waitcnt vmcnt(37)
v_mfma_f32_16x16x32_bf16 v[80:83], a[96:99], v[16:19], 0
v_mfma_f32_16x16x32_bf16 v[84:87], a[104:107], v[16:19], 0
v_mfma_f32_16x16x32_bf16 v[88:91], a[112:115], v[16:19], 0
v_mfma_f32_16x16x32_bf16 v[92:95], a[120:123], v[16:19], 0
v_mfma_f32_16x16x32_bf16 v[80:83], a[100:103], v[20:23], v[80:83]
v_mfma_f32_16x16x32_bf16 v[84:87], a[108:111], v[20:23], v[84:87]
v_mfma_f32_16x16x32_bf16 v[88:91], a[116:119], v[20:23], v[88:91]
v_mfma_f32_16x16x32_bf16 v[92:95], a[124:127], v[20:23], v[92:95]
v_permlane32_swap_b32 v64, v68
v_permlane32_swap_b32 v65, v69
v_permlane32_swap_b32 v66, v70
v_permlane32_swap_b32 v67, v71
v_permlane32_swap_b32 v72, v76
v_permlane32_swap_b32 v73, v77
v_permlane32_swap_b32 v74, v78
v_permlane32_swap_b32 v75, v79
v_add_f32_dpp v64, v68, v64 row_ror:8 row_mask:0xf bank_mask:0xf
v_add_f32_dpp v65, v69, v65 row_ror:8 row_mask:0xf bank_mask:0xf
v_add_f32_dpp v66, v70, v66 row_ror:8 row_mask:0xf bank_mask:0xf
v_add_f32_dpp v67, v71, v67 row_ror:8 row_mask:0xf bank_mask:0xf
v_add_f32_dpp v72, v76, v72 row_ror:8 row_mask:0xf bank_mask:0xf
v_add_f32_dpp v73, v77, v73 row_ror:8 row_mask:0xf bank_mask:0xf
v_add_f32_dpp v74, v78, v74 row_ror:8 row_mask:0xf bank_mask:0xf
v_add_f32_dpp v75, v79, v75 row_ror:8 row_mask:0xf bank_mask:0xf
s_add_u32 s72, s72, 4096
buffer_load_dwordx4 v[132:135], v3, s[12:15], s72 offen nt
v_cvt_pk_bf16_f32 v68, v64, v65
v_cvt_pk_bf16_f32 v69, v66, v67
v_cvt_pk_bf16_f32 v70, v72, v73
v_cvt_pk_bf16_f32 v71, v74, v75
v_lshlrev_b32 v24, 16, v68
v_and_b32 v25, 0xffff0000, v68
v_lshlrev_b32 v26, 16, v69
v_and_b32 v27, 0xffff0000, v69
v_lshlrev_b32 v28, 16, v70
v_and_b32 v29, 0xffff0000, v70
v_lshlrev_b32 v30, 16, v71
v_and_b32 v31, 0xffff0000, v71
v_mul_f32 v24, s59, v24
v_mul_f32 v25, s59, v25
v_mul_f32 v26, s59, v26
v_mul_f32 v27, s59, v27
v_mul_f32 v28, s59, v28
v_mul_f32 v29, s59, v29
v_mul_f32 v30, s59, v30
v_mul_f32 v31, s59, v31
s_add_u32 s72, s72, 4096
buffer_load_dwordx4 v[136:139], v3, s[12:15], s72 offen nt
v_cvt_pk_bf16_f32 v40, v24, v25
v_max3_f32 v9, v9, v24, v25
v_cvt_pk_bf16_f32 v41, v26, v27
v_max3_f32 v9, v9, v26, v27
v_cvt_pk_bf16_f32 v42, v28, v29
v_max3_f32 v9, v9, v28, v29
v_cvt_pk_bf16_f32 v43, v30, v31
v_max3_f32 v9, v9, v30, v31
s_waitcnt vmcnt(31)
v_mfma_f32_16x16x32_bf16 v[64:67], a[128:131], v[16:19], 0
v_mfma_f32_16x16x32_bf16 v[68:71], a[136:139], v[16:19], 0
v_mfma_f32_16x16x32_bf16 v[72:75], a[144:147], v[16:19], 0
v_mfma_f32_16x16x32_bf16 v[76:79], a[152:155], v[16:19], 0
v_mfma_f32_16x16x32_bf16 v[64:67], a[132:135], v[20:23], v[64:67]
v_mfma_f32_16x16x32_bf16 v[68:71], a[140:143], v[20:23], v[68:71]
v_mfma_f32_16x16x32_bf16 v[72:75], a[148:151], v[20:23], v[72:75]
v_mfma_f32_16x16x32_bf16 v[76:79], a[156:159], v[20:23], v[76:79]
v_permlane32_swap_b32 v80, v84
v_permlane32_swap_b32 v81, v85
v_permlane32_swap_b32 v82, v86
v_permlane32_swap_b32 v83, v87
v_permlane32_swap_b32 v88, v92
v_permlane32_swap_b32 v89, v93
v_permlane32_swap_b32 v90, v94
v_permlane32_swap_b32 v91, v95
v_add_f32_dpp v80, v84, v80 row_ror:8 row_mask:0xf bank_mask:0xf
v_add_f32_dpp v81, v85, v81 row_ror:8 row_mask:0xf bank_mask:0xf
v_add_f32_dpp v82, v86, v82 row_ror:8 row_mask:0xf bank_mask:0xf
v_add_f32_dpp v83, v87, v83 row_ror:8 row_mask:0xf bank_mask:0xf
v_add_f32_dpp v88, v92, v88 row_ror:8 row_mask:0xf bank_mask:0xf
v_add_f32_dpp v89, v93, v89 row_ror:8 row_mask:0xf bank_mask:0xf
v_add_f32_dpp v90, v94, v90 row_ror:8 row_mask:0xf bank_mask:0xf
v_add_f32_dpp v91, v95, v91 row_ror:8 row_mask:0xf bank_mask:0xf
s_add_u32 s72, s72, 4096
buffer_load_dwordx4 v[140:143], v3, s[12:15], s72 offen nt
v_cvt_pk_bf16_f32 v84, v80, v81
v_cvt_pk_bf16_f32 v85, v82, v83
v_cvt_pk_bf16_f32 v86, v88, v89
v_cvt_pk_bf16_f32 v87, v90, v91
v_lshlrev_b32 v24, 16, v84
v_and_b32 v25, 0xffff0000, v84
v_lshlrev_b32 v26, 16, v85
v_and_b32 v27, 0xffff0000, v85
v_lshlrev_b32 v28, 16, v86
v_and_b32 v29, 0xffff0000, v86
v_lshlrev_b32 v30, 16, v87
v_and_b32 v31, 0xffff0000, v87
v_mul_f32 v24, s59, v24
v_mul_f32 v25, s59, v25
v_mul_f32 v26, s59, v26
v_mul_f32 v27, s59, v27
v_mul_f32 v28, s59, v28
v_mul_f32 v29, s59, v29
v_mul_f32 v30, s59, v30
v_mul_f32 v31, s59, v31
s_add_u32 s72, s72, 4096
buffer_load_dwordx4 v[144:147], v3, s[12:15], s72 offen nt
v_cvt_pk_bf16_f32 v44, v24, v25
v_max3_f32 v9, v9, v24, v25
v_cvt_pk_bf16_f32 v45, v26, v27
v_max3_f32 v9, v9, v26, v27
v_cvt_pk_bf16_f32 v46, v28, v29
v_max3_f32 v9, v9, v28, v29
v_cvt_pk_bf16_f32 v47, v30, v31
v_max3_f32 v9, v9, v30, v31
s_waitcnt vmcnt(25)
v_mfma_f32_16x16x32_bf16 v[80:83], a[160:163], v[16:19], 0
v_mfma_f32_16x16x32_bf16 v[84:87], a[168:171], v[16:19], 0
v_mfma_f32_16x16x32_bf16 v[88:91], a[176:179], v[16:19], 0
v_mfma_f32_16x16x32_bf16 v[92:95], a[184:187], v[16:19], 0
v_mfma_f32_16x16x32_bf16 v[80:83], a[164:167], v[20:23], v[80:83]
v_mfma_f32_16x16x32_bf16 v[84:87], a[172:175], v[20:23], v[84:87]
v_mfma_f32_16x16x32_bf16 v[88:91], a[180:183], v[20:23], v[88:91]
v_mfma_f32_16x16x32_bf16 v[92:95], a[188:191], v[20:23], v[92:95]
v_permlane32_swap_b32 v64, v68
v_permlane32_swap_b32 v65, v69
v_permlane32_swap_b32 v66, v70
v_permlane32_swap_b32 v67, v71
v_permlane32_swap_b32 v72, v76
v_permlane32_swap_b32 v73, v77
v_permlane32_swap_b32 v74, v78
v_permlane32_swap_b32 v75, v79
v_add_f32_dpp v64, v68, v64 row_ror:8 row_mask:0xf bank_mask:0xf
v_add_f32_dpp v65, v69, v65 row_ror:8 row_mask:0xf bank_mask:0xf
v_add_f32_dpp v66, v70, v66 row_ror:8 row_mask:0xf bank_mask:0xf
v_add_f32_dpp v67, v71, v67 row_ror:8 row_mask:0xf bank_mask:0xf
v_add_f32_dpp v72, v76, v72 row_ror:8 row_mask:0xf bank_mask:0xf
v_add_f32_dpp v73, v77, v73 row_ror:8 row_mask:0xf bank_mask:0xf
v_add_f32_dpp v74, v78, v74 row_ror:8 row_mask:0xf bank_mask:0xf
v_add_f32_dpp v75, v79, v75 row_ror:8 row_mask:0xf bank_mask:0xf
s_add_u32 s72, s72, 4096
buffer_load_dwordx4 v[148:151], v3, s[12:15], s72 offen nt
v_cvt_pk_bf16_f32 v68, v64, v65
v_cvt_pk_bf16_f32 v69, v66, v67
v_cvt_pk_bf16_f32 v70, v72, v73
v_cvt_pk_bf16_f32 v71, v74, v75
v_lshlrev_b32 v24, 16, v68
v_and_b32 v25, 0xffff0000, v68
v_lshlrev_b32 v26, 16, v69
v_and_b32 v27, 0xffff0000, v69
v_lshlrev_b32 v28, 16, v70
v_and_b32 v29, 0xffff0000, v70
v_lshlrev_b32 v30, 16, v71
v_and_b32 v31, 0xffff0000, v71
v_mul_f32 v24, s59, v24
v_mul_f32 v25, s59, v25
v_mul_f32 v26, s59, v26
v_mul_f32 v27, s59, v27
v_mul_f32 v28, s59, v28
v_mul_f32 v29, s59, v29
v_mul_f32 v30, s59, v30
v_mul_f32 v31, s59, v31
s_add_u32 s72, s72, 4096
buffer_load_dwordx4 v[152:155], v3, s[12:15], s72 offen nt
v_cvt_pk_bf16_f32 v48, v24, v25
v_max3_f32 v9, v9, v24, v25
v_cvt_pk_bf16_f32 v49, v26, v27
v_max3_f32 v9, v9, v26, v27
v_cvt_pk_bf16_f32 v50, v28, v29
v_max3_f32 v9, v9, v28, v29
v_cvt_pk_bf16_f32 v51, v30, v31
v_max3_f32 v9, v9, v30, v31
s_waitcnt vmcnt(15)
v_mfma_f32_16x16x32_bf16 v[64:67], a[192:195], v[16:19], 0
v_mfma_f32_16x16x32_bf16 v[68:71], a[200:203], v[16:19], 0
v_mfma_f32_16x16x32_bf16 v[72:75], a[208:211], v[16:19], 0
v_mfma_f32_16x16x32_bf16 v[76:79], a[216:219], v[16:19], 0
v_mfma_f32_16x16x32_bf16 v[64:67], a[196:199], v[20:23], v[64:67]
v_mfma_f32_16x16x32_bf16 v[68:71], a[204:207], v[20:23], v[68:71]
v_mfma_f32_16x16x32_bf16 v[72:75], a[212:215], v[20:23], v[72:75]
v_mfma_f32_16x16x32_bf16 v[76:79], a[220:223], v[20:23], v[76:79]
v_permlane32_swap_b32 v80, v84
v_permlane32_swap_b32 v81, v85
v_permlane32_swap_b32 v82, v86
v_permlane32_swap_b32 v83, v87
v_permlane32_swap_b32 v88, v92
v_permlane32_swap_b32 v89, v93
v_permlane32_swap_b32 v90, v94
v_permlane32_swap_b32 v91, v95
v_add_f32_dpp v80, v84, v80 row_ror:8 row_mask:0xf bank_mask:0xf
v_add_f32_dpp v81, v85, v81 row_ror:8 row_mask:0xf bank_mask:0xf
v_add_f32_dpp v82, v86, v82 row_ror:8 row_mask:0xf bank_mask:0xf
v_add_f32_dpp v83, v87, v83 row_ror:8 row_mask:0xf bank_mask:0xf
v_add_f32_dpp v88, v92, v88 row_ror:8 row_mask:0xf bank_mask:0xf
v_add_f32_dpp v89, v93, v89 row_ror:8 row_mask:0xf bank_mask:0xf
v_add_f32_dpp v90, v94, v90 row_ror:8 row_mask:0xf bank_mask:0xf
v_add_f32_dpp v91, v95, v91 row_ror:8 row_mask:0xf bank_mask:0xf
s_add_u32 s72, s72, 4096
buffer_load_dwordx4 v[156:159], v3, s[12:15], s72 offen nt
v_cvt_pk_bf16_f32 v84, v80, v81
v_cvt_pk_bf16_f32 v85, v82, v83
v_cvt_pk_bf16_f32 v86, v88, v89
v_cvt_pk_bf16_f32 v87, v90, v91
v_lshlrev_b32 v24, 16, v84
v_and_b32 v25, 0xffff0000, v84
v_lshlrev_b32 v26, 16, v85
v_and_b32 v27, 0xffff0000, v85
v_lshlrev_b32 v28, 16, v86
v_and_b32 v29, 0xffff0000, v86
v_lshlrev_b32 v30, 16, v87
v_and_b32 v31, 0xffff0000, v87
v_mul_f32 v24, s59, v24
v_mul_f32 v25, s59, v25
v_mul_f32 v26, s59, v26
v_mul_f32 v27, s59, v27
v_mul_f32 v28, s59, v28
v_mul_f32 v29, s59, v29
v_mul_f32 v30, s59, v30
v_mul_f32 v31, s59, v31
s_add_u32 s72, s52, 32768
buffer_load_dwordx4 v[160:163], v3, s[12:15], s72 offen nt
v_cvt_pk_bf16_f32 v52, v24, v25
v_max3_f32 v9, v9, v24, v25
v_cvt_pk_bf16_f32 v53, v26, v27
v_max3_f32 v9, v9, v26, v27
v_cvt_pk_bf16_f32 v54, v28, v29
v_max3_f32 v9, v9, v28, v29
v_cvt_pk_bf16_f32 v55, v30, v31
v_max3_f32 v9, v9, v30, v31
s_waitcnt vmcnt(9)
v_mfma_f32_16x16x32_bf16 v[80:83], a[224:227], v[16:19], 0
v_mfma_f32_16x16x32_bf16 v[84:87], a[232:235], v[16:19], 0
v_mfma_f32_16x16x32_bf16 v[88:91], a[240:243], v[16:19], 0
v_mfma_f32_16x16x32_bf16 v[92:95], a[248:251], v[16:19], 0
v_mfma_f32_16x16x32_bf16 v[80:83], a[228:231], v[20:23], v[80:83]
v_mfma_f32_16x16x32_bf16 v[84:87], a[236:239], v[20:23], v[84:87]
v_mfma_f32_16x16x32_bf16 v[88:91], a[244:247], v[20:23], v[88:91]
v_mfma_f32_16x16x32_bf16 v[92:95], a[252:255], v[20:23], v[92:95]
v_permlane32_swap_b32 v64, v68
v_permlane32_swap_b32 v65, v69
v_permlane32_swap_b32 v66, v70
v_permlane32_swap_b32 v67, v71
v_permlane32_swap_b32 v72, v76
v_permlane32_swap_b32 v73, v77
v_permlane32_swap_b32 v74, v78
v_permlane32_swap_b32 v75, v79
v_add_f32_dpp v64, v68, v64 row_ror:8 row_mask:0xf bank_mask:0xf
v_add_f32_dpp v65, v69, v65 row_ror:8 row_mask:0xf bank_mask:0xf
v_add_f32_dpp v66, v70, v66 row_ror:8 row_mask:0xf bank_mask:0xf
v_add_f32_dpp v67, v71, v67 row_ror:8 row_mask:0xf bank_mask:0xf
v_add_f32_dpp v72, v76, v72 row_ror:8 row_mask:0xf bank_mask:0xf
v_add_f32_dpp v73, v77, v73 row_ror:8 row_mask:0xf bank_mask:0xf
v_add_f32_dpp v74, v78, v74 row_ror:8 row_mask:0xf bank_mask:0xf
v_add_f32_dpp v75, v79, v75 row_ror:8 row_mask:0xf bank_mask:0xf
s_add_u32 s72, s72, 4096
buffer_load_dwordx4 v[164:167], v3, s[12:15], s72 offen nt
v_cvt_pk_bf16_f32 v68, v64, v65
v_cvt_pk_bf16_f32 v69, v66, v67
v_cvt_pk_bf16_f32 v70, v72, v73
v_cvt_pk_bf16_f32 v71, v74, v75
v_lshlrev_b32 v24, 16, v68
v_and_b32 v25, 0xffff0000, v68
v_lshlrev_b32 v26, 16, v69
v_and_b32 v27, 0xffff0000, v69
v_lshlrev_b32 v28, 16, v70
v_and_b32 v29, 0xffff0000, v70
v_lshlrev_b32 v30, 16, v71
v_and_b32 v31, 0xffff0000, v71
v_mul_f32 v24, s59, v24
v_mul_f32 v25, s59, v25
v_mul_f32 v26, s59, v26
v_mul_f32 v27, s59, v27
v_mul_f32 v28, s59, v28
v_mul_f32 v29, s59, v29
v_mul_f32 v30, s59, v30
v_mul_f32 v31, s59, v31
s_add_u32 s72, s72, 4096
buffer_load_dwordx4 v[168:171], v3, s[12:15], s72 offen nt
v_cvt_pk_bf16_f32 v56, v24, v25
v_max3_f32 v9, v9, v24, v25
v_cvt_pk_bf16_f32 v57, v26, v27
v_max3_f32 v9, v9, v26, v27
v_cvt_pk_bf16_f32 v58, v28, v29
v_max3_f32 v9, v9, v28, v29
v_cvt_pk_bf16_f32 v59, v30, v31
v_max3_f32 v9, v9, v30, v31
v_permlane32_swap_b32 v80, v84
v_permlane32_swap_b32 v81, v85
v_permlane32_swap_b32 v82, v86
v_permlane32_swap_b32 v83, v87
v_permlane32_swap_b32 v88, v92
v_permlane32_swap_b32 v89, v93
v_permlane32_swap_b32 v90, v94
v_permlane32_swap_b32 v91, v95
v_add_f32_dpp v80, v84, v80 row_ror:8 row_mask:0xf bank_mask:0xf
v_add_f32_dpp v81, v85, v81 row_ror:8 row_mask:0xf bank_mask:0xf
v_add_f32_dpp v82, v86, v82 row_ror:8 row_mask:0xf bank_mask:0xf
v_add_f32_dpp v83, v87, v83 row_ror:8 row_mask:0xf bank_mask:0xf
v_add_f32_dpp v88, v92, v88 row_ror:8 row_mask:0xf bank_mask:0xf
v_add_f32_dpp v89, v93, v89 row_ror:8 row_mask:0xf bank_mask:0xf
v_add_f32_dpp v90, v94, v90 row_ror:8 row_mask:0xf bank_mask:0xf
v_add_f32_dpp v91, v95, v91 row_ror:8 row_mask:0xf bank_mask:0xf
s_add_u32 s72, s72, 4096
buffer_load_dwordx4 v[172:175], v3, s[12:15], s72 offen nt
v_cvt_pk_bf16_f32 v84, v80, v81
v_cvt_pk_bf16_f32 v85, v82, v83
v_cvt_pk_bf16_f32 v86, v88, v89
v_cvt_pk_bf16_f32 v87, v90, v91
v_lshlrev_b32 v24, 16, v84
v_and_b32 v25, 0xffff0000, v84
v_lshlrev_b32 v26, 16, v85
v_and_b32 v27, 0xffff0000, v85
v_lshlrev_b32 v28, 16, v86
v_and_b32 v29, 0xffff0000, v86
v_lshlrev_b32 v30, 16, v87
v_and_b32 v31, 0xffff0000, v87
v_mul_f32 v24, s59, v24
v_mul_f32 v25, s59, v25
v_mul_f32 v26, s59, v26
v_mul_f32 v27, s59, v27
v_mul_f32 v28, s59, v28
v_mul_f32 v29, s59, v29
v_mul_f32 v30, s59, v30
v_mul_f32 v31, s59, v31
s_add_u32 s72, s72, 4096
buffer_load_dwordx4 v[176:179], v3, s[12:15], s72 offen nt
v_cvt_pk_bf16_f32 v60, v24, v25
v_max3_f32 v9, v9, v24, v25
v_cvt_pk_bf16_f32 v61, v26, v27
v_max3_f32 v9, v9, v26, v27
v_cvt_pk_bf16_f32 v62, v28, v29
v_max3_f32 v9, v9, v28, v29
v_cvt_pk_bf16_f32 v63, v30, v31
v_max3_f32 v9, v9, v30, v31
v_mov_b32 v12, v9
s_nop 1
v_permlane16_swap_b32 v9, v12
v_max_f32 v9, v9, v12
v_mov_b32 v12, v9
s_nop 1
v_permlane32_swap_b32 v9, v12
v_max_f32 v9, v9, v12
v_cvt_pk_bf16_f32 v12, v9, v9
v_lshlrev_b32 v9, 16, v12
v_mul_f32 v14, s58, v9
v_sub_f32 v14, 0, v14
v_mov_b32 v10, 0
v_mov_b32 v11, 0
v_lshlrev_b32 v64, 16, v32
v_and_b32 v65, 0xffff0000, v32
v_lshlrev_b32 v66, 16, v33
v_and_b32 v67, 0xffff0000, v33
v_lshlrev_b32 v68, 16, v34
v_and_b32 v69, 0xffff0000, v34
v_lshlrev_b32 v70, 16, v35
v_and_b32 v71, 0xffff0000, v35
v_fma_f32 v64, v64, s58, v14
v_fma_f32 v65, v65, s58, v14
v_fma_f32 v66, v66, s58, v14
v_fma_f32 v67, v67, s58, v14
v_fma_f32 v68, v68, s58, v14
v_fma_f32 v69, v69, s58, v14
v_fma_f32 v70, v70, s58, v14
v_fma_f32 v71, v71, s58, v14
v_exp_f32 v64, v64
v_exp_f32 v65, v65
v_exp_f32 v66, v66
v_exp_f32 v67, v67
v_exp_f32 v68, v68
v_exp_f32 v69, v69
v_exp_f32 v70, v70
v_exp_f32 v71, v71
v_cvt_pk_bf16_f32 v32, v64, v65
v_add_f32 v10, v10, v64
v_add_f32 v11, v11, v65
v_cvt_pk_bf16_f32 v33, v66, v67
v_add_f32 v10, v10, v66
v_add_f32 v11, v11, v67
v_cvt_pk_bf16_f32 v34, v68, v69
v_add_f32 v10, v10, v68
v_add_f32 v11, v11, v69
v_cvt_pk_bf16_f32 v35, v70, v71
v_add_f32 v10, v10, v70
v_add_f32 v11, v11, v71
s_add_u32 s72, s72, 4096
buffer_load_dwordx4 v[180:183], v3, s[12:15], s72 offen nt
v_lshlrev_b32 v72, 16, v36
v_and_b32 v73, 0xffff0000, v36
v_lshlrev_b32 v74, 16, v37
v_and_b32 v75, 0xffff0000, v37
v_lshlrev_b32 v76, 16, v38
v_and_b32 v77, 0xffff0000, v38
v_lshlrev_b32 v78, 16, v39
v_and_b32 v79, 0xffff0000, v39
v_fma_f32 v72, v72, s58, v14
v_fma_f32 v73, v73, s58, v14
v_fma_f32 v74, v74, s58, v14
v_fma_f32 v75, v75, s58, v14
v_fma_f32 v76, v76, s58, v14
v_fma_f32 v77, v77, s58, v14
v_fma_f32 v78, v78, s58, v14
v_fma_f32 v79, v79, s58, v14
v_exp_f32 v72, v72
v_exp_f32 v73, v73
v_exp_f32 v74, v74
v_exp_f32 v75, v75
v_exp_f32 v76, v76
v_exp_f32 v77, v77
v_exp_f32 v78, v78
v_exp_f32 v79, v79
v_cvt_pk_bf16_f32 v36, v72, v73
v_add_f32 v10, v10, v72
v_add_f32 v11, v11, v73
v_cvt_pk_bf16_f32 v37, v74, v75
v_add_f32 v10, v10, v74
v_add_f32 v11, v11, v75
v_cvt_pk_bf16_f32 v38, v76, v77
v_add_f32 v10, v10, v76
v_add_f32 v11, v11, v77
v_cvt_pk_bf16_f32 v39, v78, v79
v_add_f32 v10, v10, v78
v_add_f32 v11, v11, v79
s_add_u32 s72, s72, 4096
buffer_load_dwordx4 v[184:187], v3, s[12:15], s72 offen nt
v_lshlrev_b32 v64, 16, v40
v_and_b32 v65, 0xffff0000, v40
v_lshlrev_b32 v66, 16, v41
v_and_b32 v67, 0xffff0000, v41
v_lshlrev_b32 v68, 16, v42
v_and_b32 v69, 0xffff0000, v42
v_lshlrev_b32 v70, 16, v43
v_and_b32 v71, 0xffff0000, v43
v_fma_f32 v64, v64, s58, v14
v_fma_f32 v65, v65, s58, v14
v_fma_f32 v66, v66, s58, v14
v_fma_f32 v67, v67, s58, v14
v_fma_f32 v68, v68, s58, v14
v_fma_f32 v69, v69, s58, v14
v_fma_f32 v70, v70, s58, v14
v_fma_f32 v71, v71, s58, v14
v_exp_f32 v64, v64
v_exp_f32 v65, v65
v_exp_f32 v66, v66
v_exp_f32 v67, v67
v_exp_f32 v68, v68
v_exp_f32 v69, v69
v_exp_f32 v70, v70
v_exp_f32 v71, v71
v_cvt_pk_bf16_f32 v40, v64, v65
v_add_f32 v10, v10, v64
v_add_f32 v11, v11, v65
v_cvt_pk_bf16_f32 v41, v66, v67
v_add_f32 v10, v10, v66
v_add_f32 v11, v11, v67
v_cvt_pk_bf16_f32 v42, v68, v69
v_add_f32 v10, v10, v68
v_add_f32 v11, v11, v69
v_cvt_pk_bf16_f32 v43, v70, v71
v_add_f32 v10, v10, v70
v_add_f32 v11, v11, v71
s_add_u32 s72, s72, 4096
buffer_load_dwordx4 v[188:191], v3, s[12:15], s72 offen nt
v_lshlrev_b32 v72, 16, v44
v_and_b32 v73, 0xffff0000, v44
v_lshlrev_b32 v74, 16, v45
v_and_b32 v75, 0xffff0000, v45
v_lshlrev_b32 v76, 16, v46
v_and_b32 v77, 0xffff0000, v46
v_lshlrev_b32 v78, 16, v47
v_and_b32 v79, 0xffff0000, v47
v_fma_f32 v72, v72, s58, v14
v_fma_f32 v73, v73, s58, v14
v_fma_f32 v74, v74, s58, v14
v_fma_f32 v75, v75, s58, v14
v_fma_f32 v76, v76, s58, v14
v_fma_f32 v77, v77, s58, v14
v_fma_f32 v78, v78, s58, v14
v_fma_f32 v79, v79, s58, v14
v_exp_f32 v72, v72
v_exp_f32 v73, v73
v_exp_f32 v74, v74
v_exp_f32 v75, v75
v_exp_f32 v76, v76
v_exp_f32 v77, v77
v_exp_f32 v78, v78
v_exp_f32 v79, v79
v_cvt_pk_bf16_f32 v44, v72, v73
v_add_f32 v10, v10, v72
v_add_f32 v11, v11, v73
v_cvt_pk_bf16_f32 v45, v74, v75
v_add_f32 v10, v10, v74
v_add_f32 v11, v11, v75
v_cvt_pk_bf16_f32 v46, v76, v77
v_add_f32 v10, v10, v76
v_add_f32 v11, v11, v77
v_cvt_pk_bf16_f32 v47, v78, v79
v_add_f32 v10, v10, v78
v_add_f32 v11, v11, v79
s_add_u32 s72, s52, 65536
buffer_load_dwordx4 v[192:195], v3, s[12:15], s72 offen nt
v_lshlrev_b32 v64, 16, v48
v_and_b32 v65, 0xffff0000, v48
v_lshlrev_b32 v66, 16, v49
v_and_b32 v67, 0xffff0000, v49
v_lshlrev_b32 v68, 16, v50
v_and_b32 v69, 0xffff0000, v50
v_lshlrev_b32 v70, 16, v51
v_and_b32 v71, 0xffff0000, v51
v_fma_f32 v64, v64, s58, v14
v_fma_f32 v65, v65, s58, v14
v_fma_f32 v66, v66, s58, v14
v_fma_f32 v67, v67, s58, v14
v_fma_f32 v68, v68, s58, v14
v_fma_f32 v69, v69, s58, v14
v_fma_f32 v70, v70, s58, v14
v_fma_f32 v71, v71, s58, v14
v_exp_f32 v64, v64
v_exp_f32 v65, v65
v_exp_f32 v66, v66
v_exp_f32 v67, v67
v_exp_f32 v68, v68
v_exp_f32 v69, v69
v_exp_f32 v70, v70
v_exp_f32 v71, v71
v_cvt_pk_bf16_f32 v48, v64, v65
v_add_f32 v10, v10, v64
v_add_f32 v11, v11, v65
v_cvt_pk_bf16_f32 v49, v66, v67
v_add_f32 v10, v10, v66
v_add_f32 v11, v11, v67
v_cvt_pk_bf16_f32 v50, v68, v69
v_add_f32 v10, v10, v68
v_add_f32 v11, v11, v69
v_cvt_pk_bf16_f32 v51, v70, v71
v_add_f32 v10, v10, v70
v_add_f32 v11, v11, v71
s_add_u32 s72, s72, 4096
buffer_load_dwordx4 v[196:199], v3, s[12:15], s72 offen nt
v_lshlrev_b32 v72, 16, v52
v_and_b32 v73, 0xffff0000, v52
v_lshlrev_b32 v74, 16, v53
v_and_b32 v75, 0xffff0000, v53
v_lshlrev_b32 v76, 16, v54
v_and_b32 v77, 0xffff0000, v54
v_lshlrev_b32 v78, 16, v55
v_and_b32 v79, 0xffff0000, v55
v_fma_f32 v72, v72, s58, v14
v_fma_f32 v73, v73, s58, v14
v_fma_f32 v74, v74, s58, v14
v_fma_f32 v75, v75, s58, v14
v_fma_f32 v76, v76, s58, v14
v_fma_f32 v77, v77, s58, v14
v_fma_f32 v78, v78, s58, v14
v_fma_f32 v79, v79, s58, v14
v_exp_f32 v72, v72
v_exp_f32 v73, v73
v_exp_f32 v74, v74
v_exp_f32 v75, v75
v_exp_f32 v76, v76
v_exp_f32 v77, v77
v_exp_f32 v78, v78
v_exp_f32 v79, v79
v_cvt_pk_bf16_f32 v52, v72, v73
v_add_f32 v10, v10, v72
v_add_f32 v11, v11, v73
v_cvt_pk_bf16_f32 v53, v74, v75
v_add_f32 v10, v10, v74
v_add_f32 v11, v11, v75
v_cvt_pk_bf16_f32 v54, v76, v77
v_add_f32 v10, v10, v76
v_add_f32 v11, v11, v77
v_cvt_pk_bf16_f32 v55, v78, v79
v_add_f32 v10, v10, v78
v_add_f32 v11, v11, v79
s_add_u32 s72, s72, 4096
buffer_load_dwordx4 v[200:203], v3, s[12:15], s72 offen nt
v_lshlrev_b32 v64, 16, v56
v_and_b32 v65, 0xffff0000, v56
v_lshlrev_b32 v66, 16, v57
v_and_b32 v67, 0xffff0000, v57
v_lshlrev_b32 v68, 16, v58
v_and_b32 v69, 0xffff0000, v58
v_lshlrev_b32 v70, 16, v59
v_and_b32 v71, 0xffff0000, v59
v_fma_f32 v64, v64, s58, v14
v_fma_f32 v65, v65, s58, v14
v_fma_f32 v66, v66, s58, v14
v_fma_f32 v67, v67, s58, v14
v_fma_f32 v68, v68, s58, v14
v_fma_f32 v69, v69, s58, v14
v_fma_f32 v70, v70, s58, v14
v_fma_f32 v71, v71, s58, v14
v_exp_f32 v64, v64
v_exp_f32 v65, v65
v_exp_f32 v66, v66
v_exp_f32 v67, v67
v_exp_f32 v68, v68
v_exp_f32 v69, v69
v_exp_f32 v70, v70
v_exp_f32 v71, v71
v_cvt_pk_bf16_f32 v56, v64, v65
v_add_f32 v10, v10, v64
v_add_f32 v11, v11, v65
v_cvt_pk_bf16_f32 v57, v66, v67
v_add_f32 v10, v10, v66
v_add_f32 v11, v11, v67
v_cvt_pk_bf16_f32 v58, v68, v69
v_add_f32 v10, v10, v68
v_add_f32 v11, v11, v69
v_cvt_pk_bf16_f32 v59, v70, v71
v_add_f32 v10, v10, v70
v_add_f32 v11, v11, v71
s_add_u32 s72, s72, 4096
buffer_load_dwordx4 v[204:207], v3, s[12:15], s72 offen nt
v_lshlrev_b32 v72, 16, v60
v_and_b32 v73, 0xffff0000, v60
v_lshlrev_b32 v74, 16, v61
v_and_b32 v75, 0xffff0000, v61
v_lshlrev_b32 v76, 16, v62
v_and_b32 v77, 0xffff0000, v62
v_lshlrev_b32 v78, 16, v63
v_and_b32 v79, 0xffff0000, v63
v_fma_f32 v72, v72, s58, v14
v_fma_f32 v73, v73, s58, v14
v_fma_f32 v74, v74, s58, v14
v_fma_f32 v75, v75, s58, v14
v_fma_f32 v76, v76, s58, v14
v_fma_f32 v77, v77, s58, v14
v_fma_f32 v78, v78, s58, v14
v_fma_f32 v79, v79, s58, v14
v_exp_f32 v72, v72
v_exp_f32 v73, v73
v_exp_f32 v74, v74
v_exp_f32 v75, v75
v_exp_f32 v76, v76
v_exp_f32 v77, v77
v_exp_f32 v78, v78
v_exp_f32 v79, v79
v_cvt_pk_bf16_f32 v60, v72, v73
v_add_f32 v10, v10, v72
v_add_f32 v11, v11, v73
v_cvt_pk_bf16_f32 v61, v74, v75
v_add_f32 v10, v10, v74
v_add_f32 v11, v11, v75
v_cvt_pk_bf16_f32 v62, v76, v77
v_add_f32 v10, v10, v76
v_add_f32 v11, v11, v77
v_cvt_pk_bf16_f32 v63, v78, v79
v_add_f32 v10, v10, v78
v_add_f32 v11, v11, v79
s_add_u32 s72, s72, 4096
buffer_load_dwordx4 v[208:211], v3, s[12:15], s72 offen nt
s_add_u32 s72, s72, 4096
buffer_load_dwordx4 v[212:215], v3, s[12:15], s72 offen nt
s_add_u32 s72, s72, 4096
buffer_load_dwordx4 v[216:219], v3, s[12:15], s72 offen nt
s_add_u32 s72, s72, 4096
buffer_load_dwordx4 v[220:223], v3, s[12:15], s72 offen nt
s_add_u32 s72, s52, 98304
buffer_load_dwordx4 v[224:227], v3, s[12:15], s72 offen nt
s_add_u32 s72, s72, 4096
buffer_load_dwordx4 v[228:231], v3, s[12:15], s72 offen nt
s_add_u32 s72, s72, 4096
buffer_load_dwordx4 v[232:235], v3, s[12:15], s72 offen nt
s_add_u32 s72, s72, 4096
buffer_load_dwordx4 v[236:239], v3, s[12:15], s72 offen nt
s_add_u32 s72, s72, 4096
buffer_load_dwordx4 v[240:243], v3, s[12:15], s72 offen nt
s_add_u32 s72, s72, 4096
buffer_load_dwordx4 v[244:247], v3, s[12:15], s72 offen nt
s_add_u32 s72, s72, 4096
buffer_load_dwordx4 v[248:251], v3, s[12:15], s72 offen nt
s_add_u32 s72, s72, 4096
buffer_load_dwordx4 v[252:255], v3, s[12:15], s72 offen nt
v_add_f32 v10, v10, v11
v_mov_b32 v12, v10
s_nop 1
v_permlane16_swap_b32 v10, v12
v_add_f32 v10, v10, v12
v_mov_b32 v12, v10
s_nop 1
v_permlane32_swap_b32 v10, v12
v_add_f32 v10, v10, v12
v_mov_b32 v12, v9
v_mov_b32 v13, v10
v_and_b32 v10, 7, v1
v_lshlrev_b32 v10, 5, v10
s_lshl_b32 s62, s48, 3
v_add_u32 v14, s62, v10
s_mov_b32 exec_lo, 0x00ff00ff
s_mov_b32 exec_hi, 0x00ff00ff
ds_write_b64 v14, v[12:13] offset:13056
s_mov_b64 exec, -1
s_waitcnt vmcnt(24)
v_perm_b32 v64, v132, v128, s53
v_perm_b32 v65, v140, v136, s53
v_perm_b32 v66, v148, v144, s53
v_perm_b32 v67, v156, v152, s53
v_perm_b32 v68, v132, v128, s54
v_perm_b32 v69, v140, v136, s54
v_perm_b32 v70, v148, v144, s54
v_perm_b32 v71, v156, v152, s54
v_mfma_f32_16x16x32_bf16 v[96:99], v[64:67], v[32:35], 0
v_perm_b32 v72, v133, v129, s53
v_perm_b32 v73, v141, v137, s53
v_perm_b32 v74, v149, v145, s53
v_perm_b32 v75, v157, v153, s53
v_mfma_f32_16x16x32_bf16 v[100:103], v[68:71], v[32:35], 0
v_perm_b32 v76, v133, v129, s54
v_perm_b32 v77, v141, v137, s54
v_perm_b32 v78, v149, v145, s54
v_perm_b32 v79, v157, v153, s54
v_mfma_f32_16x16x32_bf16 v[104:107], v[72:75], v[32:35], 0
v_perm_b32 v80, v134, v130, s53
v_perm_b32 v81, v142, v138, s53
v_perm_b32 v82, v150, v146, s53
v_perm_b32 v83, v158, v154, s53
v_mfma_f32_16x16x32_bf16 v[108:111], v[76:79], v[32:35], 0
v_perm_b32 v84, v134, v130, s54
v_perm_b32 v85, v142, v138, s54
v_perm_b32 v86, v150, v146, s54
v_perm_b32 v87, v158, v154, s54
v_mfma_f32_16x16x32_bf16 v[112:115], v[80:83], v[32:35], 0
v_perm_b32 v88, v135, v131, s53
v_perm_b32 v89, v143, v139, s53
v_perm_b32 v90, v151, v147, s53
v_perm_b32 v91, v159, v155, s53
v_mfma_f32_16x16x32_bf16 v[116:119], v[84:87], v[32:35], 0
v_perm_b32 v92, v135, v131, s54
v_perm_b32 v93, v143, v139, s54
v_perm_b32 v94, v151, v147, s54
v_perm_b32 v95, v159, v155, s54
v_mfma_f32_16x16x32_bf16 v[120:123], v[88:91], v[32:35], 0
s_nop 0
v_mfma_f32_16x16x32_bf16 v[124:127], v[92:95], v[32:35], 0
s_add_u32 s72, s52, 131072
buffer_load_dwordx4 v[128:131], v3, s[12:15], s72 offen nt
s_add_u32 s72, s72, 4096
buffer_load_dwordx4 v[132:135], v3, s[12:15], s72 offen nt
s_add_u32 s72, s72, 4096
buffer_load_dwordx4 v[136:139], v3, s[12:15], s72 offen nt
s_add_u32 s72, s72, 4096
buffer_load_dwordx4 v[140:143], v3, s[12:15], s72 offen nt
s_add_u32 s72, s72, 4096
buffer_load_dwordx4 v[144:147], v3, s[12:15], s72 offen nt
s_add_u32 s72, s72, 4096
buffer_load_dwordx4 v[148:151], v3, s[12:15], s72 offen nt
s_add_u32 s72, s72, 4096
buffer_load_dwordx4 v[152:155], v3, s[12:15], s72 offen nt
s_add_u32 s72, s72, 4096
buffer_load_dwordx4 v[156:159], v3, s[12:15], s72 offen nt
s_waitcnt vmcnt(24)
v_perm_b32 v64, v164, v160, s53
v_perm_b32 v65, v172, v168, s53
v_perm_b32 v66, v180, v176, s53
v_perm_b32 v67, v188, v184, s53
v_perm_b32 v68, v164, v160, s54
v_perm_b32 v69, v172, v168, s54
v_perm_b32 v70, v180, v176, s54
v_perm_b32 v71, v188, v184, s54
v_mfma_f32_16x16x32_bf16 v[96:99], v[64:67], v[36:39], v[96:99]
v_perm_b32 v72, v165, v161, s53
v_perm_b32 v73, v173, v169, s53
v_perm_b32 v74, v181, v177, s53
v_perm_b32 v75, v189, v185, s53
v_mfma_f32_16x16x32_bf16 v[100:103], v[68:71], v[36:39], v[100:103]
v_perm_b32 v76, v165, v161, s54
v_perm_b32 v77, v173, v169, s54
v_perm_b32 v78, v181, v177, s54
v_perm_b32 v79, v189, v185, s54
v_mfma_f32_16x16x32_bf16 v[104:107], v[72:75], v[36:39], v[104:107]
v_perm_b32 v80, v166, v162, s53
v_perm_b32 v81, v174, v170, s53
v_perm_b32 v82, v182, v178, s53
v_perm_b32 v83, v190, v186, s53
v_mfma_f32_16x16x32_bf16 v[108:111], v[76:79], v[36:39], v[108:111]
v_perm_b32 v84, v166, v162, s54
v_perm_b32 v85, v174, v170, s54
v_perm_b32 v86, v182, v178, s54
v_perm_b32 v87, v190, v186, s54
v_mfma_f32_16x16x32_bf16 v[112:115], v[80:83], v[36:39], v[112:115]
v_perm_b32 v88, v167, v163, s53
v_perm_b32 v89, v175, v171, s53
v_perm_b32 v90, v183, v179, s53
v_perm_b32 v91, v191, v187, s53
v_mfma_f32_16x16x32_bf16 v[116:119], v[84:87], v[36:39], v[116:119]
v_perm_b32 v92, v167, v163, s54
v_perm_b32 v93, v175, v171, s54
v_perm_b32 v94, v183, v179, s54
v_perm_b32 v95, v191, v187, s54
v_mfma_f32_16x16x32_bf16 v[120:123], v[88:91], v[36:39], v[120:123]
s_nop 0
v_mfma_f32_16x16x32_bf16 v[124:127], v[92:95], v[36:39], v[124:127]
s_add_u32 s72, s52, 163840
buffer_load_dwordx4 v[160:163], v3, s[12:15], s72 offen nt
s_add_u32 s72, s72, 4096
buffer_load_dwordx4 v[164:167], v3, s[12:15], s72 offen nt
s_add_u32 s72, s72, 4096
buffer_load_dwordx4 v[168:171], v3, s[12:15], s72 offen nt
s_add_u32 s72, s72, 4096
buffer_load_dwordx4 v[172:175], v3, s[12:15], s72 offen nt
s_add_u32 s72, s72, 4096
buffer_load_dwordx4 v[176:179], v3, s[12:15], s72 offen nt
s_add_u32 s72, s72, 4096
buffer_load_dwordx4 v[180:183], v3, s[12:15], s72 offen nt
s_add_u32 s72, s72, 4096
buffer_load_dwordx4 v[184:187], v3, s[12:15], s72 offen nt
s_add_u32 s72, s72, 4096
buffer_load_dwordx4 v[188:191], v3, s[12:15], s72 offen nt
s_waitcnt vmcnt(24)
v_perm_b32 v64, v196, v192, s53
v_perm_b32 v65, v204, v200, s53
v_perm_b32 v66, v212, v208, s53
v_perm_b32 v67, v220, v216, s53
v_perm_b32 v68, v196, v192, s54
v_perm_b32 v69, v204, v200, s54
v_perm_b32 v70, v212, v208, s54
v_perm_b32 v71, v220, v216, s54
v_mfma_f32_16x16x32_bf16 v[96:99], v[64:67], v[40:43], v[96:99]
v_perm_b32 v72, v197, v193, s53
v_perm_b32 v73, v205, v201, s53
v_perm_b32 v74, v213, v209, s53
v_perm_b32 v75, v221, v217, s53
v_mfma_f32_16x16x32_bf16 v[100:103], v[68:71], v[40:43], v[100:103]
v_perm_b32 v76, v197, v193, s54
v_perm_b32 v77, v205, v201, s54
v_perm_b32 v78, v213, v209, s54
v_perm_b32 v79, v221, v217, s54
v_mfma_f32_16x16x32_bf16 v[104:107], v[72:75], v[40:43], v[104:107]
v_perm_b32 v80, v198, v194, s53
v_perm_b32 v81, v206, v202, s53
v_perm_b32 v82, v214, v210, s53
v_perm_b32 v83, v222, v218, s53
v_mfma_f32_16x16x32_bf16 v[108:111], v[76:79], v[40:43], v[108:111]
v_perm_b32 v84, v198, v194, s54
v_perm_b32 v85, v206, v202, s54
v_perm_b32 v86, v214, v210, s54
v_perm_b32 v87, v222, v218, s54
v_mfma_f32_16x16x32_bf16 v[112:115], v[80:83], v[40:43], v[112:115]
v_perm_b32 v88, v199, v195, s53
v_perm_b32 v89, v207, v203, s53
v_perm_b32 v90, v215, v211, s53
v_perm_b32 v91, v223, v219, s53
v_mfma_f32_16x16x32_bf16 v[116:119], v[84:87], v[40:43], v[116:119]
v_perm_b32 v92, v199, v195, s54
v_perm_b32 v93, v207, v203, s54
v_perm_b32 v94, v215, v211, s54
v_perm_b32 v95, v223, v219, s54
v_mfma_f32_16x16x32_bf16 v[120:123], v[88:91], v[40:43], v[120:123]
s_nop 0
v_mfma_f32_16x16x32_bf16 v[124:127], v[92:95], v[40:43], v[124:127]
s_add_u32 s72, s52, 196608
buffer_load_dwordx4 v[192:195], v3, s[12:15], s72 offen nt
s_add_u32 s72, s72, 4096
buffer_load_dwordx4 v[196:199], v3, s[12:15], s72 offen nt
s_add_u32 s72, s72, 4096
buffer_load_dwordx4 v[200:203], v3, s[12:15], s72 offen nt
s_add_u32 s72, s72, 4096
buffer_load_dwordx4 v[204:207], v3, s[12:15], s72 offen nt
s_add_u32 s72, s72, 4096
buffer_load_dwordx4 v[208:211], v3, s[12:15], s72 offen nt
s_add_u32 s72, s72, 4096
buffer_load_dwordx4 v[212:215], v3, s[12:15], s72 offen nt
s_add_u32 s72, s72, 4096
buffer_load_dwordx4 v[216:219], v3, s[12:15], s72 offen nt
s_add_u32 s72, s72, 4096
buffer_load_dwordx4 v[220:223], v3, s[12:15], s72 offen nt
s_cmp_lg_u32 s48, 0
s_cbranch_scc1 noclaim_10011
s_lshl_b32 s62, s49, 9
s_add_u32 s62, s62, 114688
s_add_u32 s82, s44, s62
s_addc_u32 s83, s45, 0
s_mov_b32 s68, 1
s_atomic_add s68, s[82:83], 0 glc
noclaim_10011:
s_waitcnt vmcnt(24)
v_perm_b32 v64, v228, v224, s53
v_perm_b32 v65, v236, v232, s53
v_perm_b32 v66, v244, v240, s53
v_perm_b32 v67, v252, v248, s53
v_perm_b32 v68, v228, v224, s54
v_perm_b32 v69, v236, v232, s54
v_perm_b32 v70, v244, v240, s54
v_perm_b32 v71, v252, v248, s54
v_mfma_f32_16x16x32_bf16 v[96:99], v[64:67], v[44:47], v[96:99]
v_perm_b32 v72, v229, v225, s53
v_perm_b32 v73, v237, v233, s53
v_perm_b32 v74, v245, v241, s53
v_perm_b32 v75, v253, v249, s53
v_mfma_f32_16x16x32_bf16 v[100:103], v[68:71], v[44:47], v[100:103]
v_perm_b32 v76, v229, v225, s54
v_perm_b32 v77, v237, v233, s54
v_perm_b32 v78, v245, v241, s54
v_perm_b32 v79, v253, v249, s54
v_mfma_f32_16x16x32_bf16 v[104:107], v[72:75], v[44:47], v[104:107]
v_perm_b32 v80, v230, v226, s53
v_perm_b32 v81, v238, v234, s53
v_perm_b32 v82, v246, v242, s53
v_perm_b32 v83, v254, v250, s53
v_mfma_f32_16x16x32_bf16 v[108:111], v[76:79], v[44:47], v[108:111]
v_perm_b32 v84, v230, v226, s54
v_perm_b32 v85, v238, v234, s54
v_perm_b32 v86, v246, v242, s54
v_perm_b32 v87, v254, v250, s54
v_mfma_f32_16x16x32_bf16 v[112:115], v[80:83], v[44:47], v[112:115]
v_perm_b32 v88, v231, v227, s53
v_perm_b32 v89, v239, v235, s53
v_perm_b32 v90, v247, v243, s53
v_perm_b32 v91, v255, v251, s53
v_mfma_f32_16x16x32_bf16 v[116:119], v[84:87], v[44:47], v[116:119]
v_perm_b32 v92, v231, v227, s54
v_perm_b32 v93, v239, v235, s54
v_perm_b32 v94, v247, v243, s54
v_perm_b32 v95, v255, v251, s54
v_mfma_f32_16x16x32_bf16 v[120:123], v[88:91], v[44:47], v[120:123]
s_nop 0
v_mfma_f32_16x16x32_bf16 v[124:127], v[92:95], v[44:47], v[124:127]
s_add_u32 s72, s52, 229376
buffer_load_dwordx4 v[224:227], v3, s[12:15], s72 offen nt
s_add_u32 s72, s72, 4096
buffer_load_dwordx4 v[228:231], v3, s[12:15], s72 offen nt
s_add_u32 s72, s72, 4096
buffer_load_dwordx4 v[232:235], v3, s[12:15], s72 offen nt
s_add_u32 s72, s72, 4096
buffer_load_dwordx4 v[236:239], v3, s[12:15], s72 offen nt
s_add_u32 s72, s72, 4096
buffer_load_dwordx4 v[240:243], v3, s[12:15], s72 offen nt
s_add_u32 s72, s72, 4096
buffer_load_dwordx4 v[244:247], v3, s[12:15], s72 offen nt
s_add_u32 s72, s72, 4096
buffer_load_dwordx4 v[248:251], v3, s[12:15], s72 offen nt
s_add_u32 s72, s72, 4096
buffer_load_dwordx4 v[252:255], v3, s[12:15], s72 offen nt
v_and_b32 v12, 7, v1
v_lshlrev_b32 v13, 9, v12
v_lshlrev_b32 v12, 4, v12
v_add_u32 v12, v12, v13
v_lshrrev_b32 v13, 4, v1
v_lshlrev_b32 v13, 7, v13
v_add_u32 v12, v12, v13
s_lshl_b32 s62, s48, 12
s_add_u32 s62, s62, 16384
v_add_u32 v24, s62, v12
v_lshlrev_b32 v25, 4, v0
v_lshrrev_b32 v14, 5, v0
v_and_b32 v15, 7, v0
v_xor_b32 v14, v14, v15
v_lshlrev_b32 v14, 4, v14
v_lshrrev_b32 v15, 3, v0
v_lshlrev_b32 v15, 7, v15
v_add_u32 v26, v14, v15
s_mul_i32 s71, s2, 4224
s_add_u32 s71, s71, 524288
v_lshrrev_b32 v13, 5, v0
v_lshlrev_b32 v27, 5, v13
v_lshlrev_b32 v28, 4, v1
v_add_u32 v28, 4096, v28
s_cmp_lg_u32 s48, 0
s_cbranch_scc1 nobc_10012
s_waitcnt lgkmcnt(0)
v_mov_b32 v12, s68
v_mov_b32 v13, 0
ds_write_b32 v13, v12 offset:14912
nobc_10012:
s_waitcnt lgkmcnt(0)
s_barrier
v_mov_b32 v13, 0
ds_read_b32 v12, v13 offset:14912
s_waitcnt lgkmcnt(0)
v_readfirstlane_b32 s66, v12
ds_read_b128 v[80:83], v27 offset:13056
ds_read_b128 v[84:87], v27 offset:13072
ds_read_b128 v[64:67], v10 offset:13056
ds_read_b128 v[68:71], v10 offset:13072
s_waitcnt lgkmcnt(2)
v_max3_f32 v12, v80, v82, v84
v_max_f32 v12, v12, v86
v_sub_f32 v80, v80, v12
v_sub_f32 v82, v82, v12
v_sub_f32 v84, v84, v12
v_sub_f32 v86, v86, v12
v_mul_f32 v80, s58, v80
v_mul_f32 v82, s58, v82
v_mul_f32 v84, s58, v84
v_mul_f32 v86, s58, v86
v_exp_f32 v16, v80
v_exp_f32 v18, v82
v_exp_f32 v20, v84
v_exp_f32 v22, v86
v_mov_b32 v17, v16
v_mov_b32 v19, v18
v_mov_b32 v21, v20
v_mov_b32 v23, v22
s_waitcnt lgkmcnt(0)
s_cmp_lg_u32 s48, 0
s_cbranch_scc1 ml_10013
v_max3_f32 v12, v64, v66, v68
v_max_f32 v12, v12, v70
v_sub_f32 v64, v64, v12
v_sub_f32 v66, v66, v12
v_sub_f32 v68, v68, v12
v_sub_f32 v70, v70, v12
v_mul_f32 v64, s58, v64
v_mul_f32 v66, s58, v66
v_mul_f32 v68, s58, v68
v_mul_f32 v70, s58, v70
v_exp_f32 v64, v64
v_exp_f32 v66, v66
v_exp_f32 v68, v68
v_exp_f32 v70, v70
v_mul_f32 v13, v64, v65
v_fmac_f32 v13, v66, v67
v_fmac_f32 v13, v68, v69
v_fmac_f32 v13, v70, v71
v_bfi_b32 v80, s57, v8, v12
v_bfi_b32 v81, s57, v8, v13
v_mov_b32 v82, s55
v_mov_b32 v83, s55
s_mov_b32 exec_lo, 0xff
s_mov_b32 exec_hi, 0
buffer_store_dwordx4 v[80:83], v28, s[44:47], s71 offen sc1
s_mov_b64 exec, -1
ml_10013:
s_cmp_ge_u32 s66, 32
s_cbranch_scc1 norole_10014
s_lshl_b32 s62, s49, 5
s_add_u32 s66, s66, s62
v_lshrrev_b32 v47, 3, v1
v_mul_u32_u24 v47, 14336, v47
v_and_b32 v13, 7, v1
v_min_u32 v13, 6, v13
v_lshlrev_b32 v13, 4, v13
v_add_u32 v47, v47, v13
s_mul_i32 s69, s66, 112
s_add_u32 s69, s69, 131072
s_add_u32 s70, s69, 114688
buffer_load_dwordx4 v[32:35], v47, s[44:47], s69 offen sc1
buffer_load_dwordx4 v[36:39], v47, s[44:47], s70 offen sc1
v_lshrrev_b32 v12, 4, v1
v_and_b32 v13, 15, v1
v_lshlrev_b32 v13, 4, v13
v_lshlrev_b32 v31, 11, v12
v_add_u32 v31, v31, v13
v_lshlrev_b32 v11, 14, v12
v_add_u32 v11, v11, v13
s_lshl_b32 s65, s48, 9
s_mul_i32 s3, s66, 57344
s_add_u32 s3, s3, s65
s_lshl_b32 s77, s66, 16
s_add_u32 s77, s77, s65
s_waitcnt vmcnt(26)
v_perm_b32 v64, v132, v128, s53
v_perm_b32 v65, v140, v136, s53
v_perm_b32 v66, v148, v144, s53
v_perm_b32 v67, v156, v152, s53
v_perm_b32 v68, v132, v128, s54
v_perm_b32 v69, v140, v136, s54
v_perm_b32 v70, v148, v144, s54
v_perm_b32 v71, v156, v152, s54
v_mfma_f32_16x16x32_bf16 v[96:99], v[64:67], v[48:51], v[96:99]
v_perm_b32 v72, v133, v129, s53
v_perm_b32 v73, v141, v137, s53
v_perm_b32 v74, v149, v145, s53
v_perm_b32 v75, v157, v153, s53
v_mfma_f32_16x16x32_bf16 v[100:103], v[68:71], v[48:51], v[100:103]
s_add_u32 s51, s3, 0
buffer_load_dwordx4 a[0:3], v31, s[32:35], s51 offen offset:0 nt
v_perm_b32 v76, v133, v129, s54
v_perm_b32 v77, v141, v137, s54
v_perm_b32 v78, v149, v145, s54
v_perm_b32 v79, v157, v153, s54
v_mfma_f32_16x16x32_bf16 v[104:107], v[72:75], v[48:51], v[104:107]
v_perm_b32 v80, v134, v130, s53
v_perm_b32 v81, v142, v138, s53
v_perm_b32 v82, v150, v146, s53
v_perm_b32 v83, v158, v154, s53
v_mfma_f32_16x16x32_bf16 v[108:111], v[76:79], v[48:51], v[108:111]
v_perm_b32 v84, v134, v130, s54
v_perm_b32 v85, v142, v138, s54
v_perm_b32 v86, v150, v146, s54
v_perm_b32 v87, v158, v154, s54
v_mfma_f32_16x16x32_bf16 v[112:115], v[80:83], v[48:51], v[112:115]
buffer_load_dwordx4 a[28:31], v31, s[32:35], s51 offen offset:256 nt
v_perm_b32 v88, v135, v131, s53
v_perm_b32 v89, v143, v139, s53
v_perm_b32 v90, v151, v147, s53
v_perm_b32 v91, v159, v155, s53
v_mfma_f32_16x16x32_bf16 v[116:119], v[84:87], v[48:51], v[116:119]
v_perm_b32 v92, v135, v131, s54
v_perm_b32 v93, v143, v139, s54
v_perm_b32 v94, v151, v147, s54
v_perm_b32 v95, v159, v155, s54
v_mfma_f32_16x16x32_bf16 v[120:123], v[88:91], v[48:51], v[120:123]
s_nop 0
v_mfma_f32_16x16x32_bf16 v[124:127], v[92:95], v[48:51], v[124:127]
s_add_u32 s51, s3, 8192
buffer_load_dwordx4 a[4:7], v31, s[32:35], s51 offen offset:0 nt
buffer_load_dwordx4 a[32:35], v31, s[32:35], s51 offen offset:256 nt
s_waitcnt vmcnt(22)
v_perm_b32 v64, v164, v160, s53
v_perm_b32 v65, v172, v168, s53
v_perm_b32 v66, v180, v176, s53
v_perm_b32 v67, v188, v184, s53
v_perm_b32 v68, v164, v160, s54
v_perm_b32 v69, v172, v168, s54
v_perm_b32 v70, v180, v176, s54
v_perm_b32 v71, v188, v184, s54
v_mfma_f32_16x16x32_bf16 v[96:99], v[64:67], v[52:55], v[96:99]
v_perm_b32 v72, v165, v161, s53
v_perm_b32 v73, v173, v169, s53
v_perm_b32 v74, v181, v177, s53
v_perm_b32 v75, v189, v185, s53
v_mfma_f32_16x16x32_bf16 v[100:103], v[68:71], v[52:55], v[100:103]
s_add_u32 s51, s3, 16384
buffer_load_dwordx4 a[8:11], v31, s[32:35], s51 offen offset:0 nt
v_perm_b32 v76, v165, v161, s54
v_perm_b32 v77, v173, v169, s54
v_perm_b32 v78, v181, v177, s54
v_perm_b32 v79, v189, v185, s54
v_mfma_f32_16x16x32_bf16 v[104:107], v[72:75], v[52:55], v[104:107]
v_perm_b32 v80, v166, v162, s53
v_perm_b32 v81, v174, v170, s53
v_perm_b32 v82, v182, v178, s53
v_perm_b32 v83, v190, v186, s53
v_mfma_f32_16x16x32_bf16 v[108:111], v[76:79], v[52:55], v[108:111]
v_perm_b32 v84, v166, v162, s54
v_perm_b32 v85, v174, v170, s54
v_perm_b32 v86, v182, v178, s54
v_perm_b32 v87, v190, v186, s54
v_mfma_f32_16x16x32_bf16 v[112:115], v[80:83], v[52:55], v[112:115]
buffer_load_dwordx4 a[36:39], v31, s[32:35], s51 offen offset:256 nt
v_perm_b32 v88, v167, v163, s53
v_perm_b32 v89, v175, v171, s53
v_perm_b32 v90, v183, v179, s53
v_perm_b32 v91, v191, v187, s53
v_mfma_f32_16x16x32_bf16 v[116:119], v[84:87], v[52:55], v[116:119]
v_perm_b32 v92, v167, v163, s54
v_perm_b32 v93, v175, v171, s54
v_perm_b32 v94, v183, v179, s54
v_perm_b32 v95, v191, v187, s54
v_mfma_f32_16x16x32_bf16 v[120:123], v[88:91], v[52:55], v[120:123]
s_nop 0
v_mfma_f32_16x16x32_bf16 v[124:127], v[92:95], v[52:55], v[124:127]
s_add_u32 s51, s3, 24576
buffer_load_dwordx4 a[12:15], v31, s[32:35], s51 offen offset:0 nt
v_lshrrev_b32 v12, 3, v1
v_mul_u32_u24 v29, 4224, v12
v_and_b32 v13, 7, v1
v_lshlrev_b32 v13, 4, v13
v_add_u32 v30, v29, v13
s_lshr_b32 s62, s66, 5
s_mul_i32 s62, s62, 270336
s_add_u32 s62, s62, 524288
s_bfe_u32 s63, s66, 0x30002
s_lshl_b32 s65, s63, 4
s_add_u32 s75, s62, s65
s_add_u32 s75, s75, 4096
s_and_b32 s63, s66, 31
s_lshl_b32 s63, s63, 7
s_add_u32 s63, s63, s62
s_mul_i32 s65, s48, 67584
s_add_u32 s74, s63, s65
s_add_u32 s76, s75, s65
buffer_load_dwordx4 a[40:43], v31, s[32:35], s51 offen offset:256 nt
s_waitcnt vmcnt(18)
v_perm_b32 v64, v196, v192, s53
v_perm_b32 v65, v204, v200, s53
v_perm_b32 v66, v212, v208, s53
v_perm_b32 v67, v220, v216, s53
v_perm_b32 v68, v196, v192, s54
v_perm_b32 v69, v204, v200, s54
v_perm_b32 v70, v212, v208, s54
v_perm_b32 v71, v220, v216, s54
v_mfma_f32_16x16x32_bf16 v[96:99], v[64:67], v[56:59], v[96:99]
v_perm_b32 v72, v197, v193, s53
v_perm_b32 v73, v205, v201, s53
v_perm_b32 v74, v213, v209, s53
v_perm_b32 v75, v221, v217, s53
v_mfma_f32_16x16x32_bf16 v[100:103], v[68:71], v[56:59], v[100:103]
s_add_u32 s51, s3, 32768
buffer_load_dwordx4 a[16:19], v31, s[32:35], s51 offen offset:0 nt
v_perm_b32 v76, v197, v193, s54
v_perm_b32 v77, v205, v201, s54
v_perm_b32 v78, v213, v209, s54
v_perm_b32 v79, v221, v217, s54
v_mfma_f32_16x16x32_bf16 v[104:107], v[72:75], v[56:59], v[104:107]
v_perm_b32 v80, v198, v194, s53
v_perm_b32 v81, v206, v202, s53
v_perm_b32 v82, v214, v210, s53
v_perm_b32 v83, v222, v218, s53
v_mfma_f32_16x16x32_bf16 v[108:111], v[76:79], v[56:59], v[108:111]
v_perm_b32 v84, v198, v194, s54
v_perm_b32 v85, v206, v202, s54
v_perm_b32 v86, v214, v210, s54
v_perm_b32 v87, v222, v218, s54
v_mfma_f32_16x16x32_bf16 v[112:115], v[80:83], v[56:59], v[112:115]
buffer_load_dwordx4 a[44:47], v31, s[32:35], s51 offen offset:256 nt
v_perm_b32 v88, v199, v195, s53
v_perm_b32 v89, v207, v203, s53
v_perm_b32 v90, v215, v211, s53
v_perm_b32 v91, v223, v219, s53
v_mfma_f32_16x16x32_bf16 v[116:119], v[84:87], v[56:59], v[116:119]
v_perm_b32 v92, v199, v195, s54
v_perm_b32 v93, v207, v203, s54
v_perm_b32 v94, v215, v211, s54
v_perm_b32 v95, v223, v219, s54
v_mfma_f32_16x16x32_bf16 v[120:123], v[88:91], v[56:59], v[120:123]
s_nop 0
v_mfma_f32_16x16x32_bf16 v[124:127], v[92:95], v[56:59], v[124:127]
s_add_u32 s51, s3, 40960
buffer_load_dwordx4 a[20:23], v31, s[32:35], s51 offen offset:0 nt
buffer_load_dwordx4 a[48:51], v31, s[32:35], s51 offen offset:256 nt
s_add_u32 s51, s3, 49152
buffer_load_dwordx4 a[24:27], v31, s[32:35], s51 offen offset:0 nt
buffer_load_dwordx4 a[52:55], v31, s[32:35], s51 offen offset:256 nt
s_waitcnt vmcnt(16)
v_perm_b32 v64, v228, v224, s53
v_perm_b32 v65, v236, v232, s53
v_perm_b32 v66, v244, v240, s53
v_perm_b32 v67, v252, v248, s53
v_perm_b32 v68, v228, v224, s54
v_perm_b32 v69, v236, v232, s54
v_perm_b32 v70, v244, v240, s54
v_perm_b32 v71, v252, v248, s54
v_mfma_f32_16x16x32_bf16 v[96:99], v[64:67], v[60:63], v[96:99]
v_perm_b32 v72, v229, v225, s53
v_perm_b32 v73, v237, v233, s53
v_perm_b32 v74, v245, v241, s53
v_perm_b32 v75, v253, v249, s53
v_mfma_f32_16x16x32_bf16 v[100:103], v[68:71], v[60:63], v[100:103]
v_perm_b32 v76, v229, v225, s54
v_perm_b32 v77, v237, v233, s54
v_perm_b32 v78, v245, v241, s54
v_perm_b32 v79, v253, v249, s54
v_mfma_f32_16x16x32_bf16 v[104:107], v[72:75], v[60:63], v[104:107]
v_perm_b32 v80, v230, v226, s53
v_perm_b32 v81, v238, v234, s53
v_perm_b32 v82, v246, v242, s53
v_perm_b32 v83, v254, v250, s53
v_mfma_f32_16x16x32_bf16 v[108:111], v[76:79], v[60:63], v[108:111]
v_perm_b32 v84, v230, v226, s54
v_perm_b32 v85, v238, v234, s54
v_perm_b32 v86, v246, v242, s54
v_perm_b32 v87, v254, v250, s54
v_mfma_f32_16x16x32_bf16 v[112:115], v[80:83], v[60:63], v[112:115]
v_perm_b32 v88, v231, v227, s53
v_perm_b32 v89, v239, v235, s53
v_perm_b32 v90, v247, v243, s53
v_perm_b32 v91, v255, v251, s53
v_mfma_f32_16x16x32_bf16 v[116:119], v[84:87], v[60:63], v[116:119]
v_perm_b32 v92, v231, v227, s54
v_perm_b32 v93, v239, v235, s54
v_perm_b32 v94, v247, v243, s54
v_perm_b32 v95, v255, v251, s54
v_mfma_f32_16x16x32_bf16 v[120:123], v[88:91], v[60:63], v[120:123]
s_nop 0
v_mfma_f32_16x16x32_bf16 v[124:127], v[92:95], v[60:63], v[124:127]
v_xor_b32 v88, 0, v24
v_xor_b32 v89, 16, v24
v_xor_b32 v90, 32, v24
v_xor_b32 v91, 48, v24
v_xor_b32 v92, 64, v24
v_xor_b32 v93, 80, v24
v_xor_b32 v94, 96, v24
v_xor_b32 v95, 112, v24
s_mov_b32 exec_lo, 0x00ff00ff
s_mov_b32 exec_hi, 0x00ff00ff
ds_write_b128 v88, v[96:99]
ds_write_b128 v89, v[100:103]
ds_write_b128 v90, v[104:107]
ds_write_b128 v91, v[108:111]
ds_write_b128 v92, v[112:115]
ds_write_b128 v93, v[116:119]
ds_write_b128 v94, v[120:123]
ds_write_b128 v95, v[124:127]
s_mov_b64 exec, -1
s_waitcnt lgkmcnt(0)
s_barrier
ds_read_b128 v[64:67], v25 offset:16384
ds_read_b128 v[68:71], v25 offset:20480
ds_read_b128 v[72:75], v25 offset:24576
ds_read_b128 v[76:79], v25 offset:28672
s_waitcnt lgkmcnt(3)
v_pk_mul_f32 v[64:65], v[16:17], v[64:65]
v_pk_mul_f32 v[66:67], v[16:17], v[66:67]
s_waitcnt lgkmcnt(2)
v_pk_fma_f32 v[64:65], v[18:19], v[68:69], v[64:65]
v_pk_fma_f32 v[66:67], v[18:19], v[70:71], v[66:67]
s_waitcnt lgkmcnt(1)
v_pk_fma_f32 v[64:65], v[20:21], v[72:73], v[64:65]
v_pk_fma_f32 v[66:67], v[20:21], v[74:75], v[66:67]
s_waitcnt lgkmcnt(0)
v_pk_fma_f32 v[64:65], v[22:23], v[76:77], v[64:65]
v_pk_fma_f32 v[66:67], v[22:23], v[78:79], v[66:67]
v_bfi_b32 v64, s57, v8, v64
v_bfi_b32 v65, s57, v8, v65
v_bfi_b32 v66, s57, v8, v66
v_bfi_b32 v67, s57, v8, v67
buffer_store_dwordx4 v[64:67], v26, s[44:47], s71 offen sc1
s_add_u32 s51, s77, 0
buffer_load_dwordx4 a[64:67], v11, s[20:23], s51 offen offset:0 nt
buffer_load_dwordx4 a[96:99], v11, s[20:23], s51 offen offset:256 nt
s_add_u32 s51, s77, 2048
buffer_load_dwordx4 a[68:71], v11, s[20:23], s51 offen offset:0 nt
buffer_load_dwordx4 a[100:103], v11, s[20:23], s51 offen offset:256 nt
s_add_u32 s51, s77, 4096
buffer_load_dwordx4 a[72:75], v11, s[20:23], s51 offen offset:0 nt
buffer_load_dwordx4 a[104:107], v11, s[20:23], s51 offen offset:256 nt
s_add_u32 s51, s77, 6144
buffer_load_dwordx4 a[76:79], v11, s[20:23], s51 offen offset:0 nt
buffer_load_dwordx4 a[108:111], v11, s[20:23], s51 offen offset:256 nt
s_add_u32 s51, s77, 8192
buffer_load_dwordx4 a[80:83], v11, s[20:23], s51 offen offset:0 nt
buffer_load_dwordx4 a[112:115], v11, s[20:23], s51 offen offset:256 nt
s_add_u32 s51, s77, 10240
buffer_load_dwordx4 a[84:87], v11, s[20:23], s51 offen offset:0 nt
buffer_load_dwordx4 a[116:119], v11, s[20:23], s51 offen offset:256 nt
s_add_u32 s51, s77, 12288
buffer_load_dwordx4 a[88:91], v11, s[20:23], s51 offen offset:0 nt
buffer_load_dwordx4 a[120:123], v11, s[20:23], s51 offen offset:256 nt
s_add_u32 s51, s77, 14336
buffer_load_dwordx4 a[92:95], v11, s[20:23], s51 offen offset:0 nt
buffer_load_dwordx4 a[124:127], v11, s[20:23], s51 offen offset:256 nt
v_bfe_u32 v12, v1, 2, 2
v_lshlrev_b32 v12, 14, v12
v_and_b32 v13, 3, v1
v_lshlrev_b32 v13, 5, v13
v_add_u32 v12, v12, v13
v_bfe_u32 v13, v1, 4, 1
v_lshlrev_b32 v13, 4, v13
v_add_u32 v160, v12, v13
s_lshl_b32 s62, s48, 17
s_lshl_b32 s65, s66, 7
s_add_u32 s62, s62, s65
s_add_u32 s72, s62, 2621440
s_add_u32 s73, s62, 2097152
v_lshrrev_b32 v12, 4, v1
v_and_b32 v13, 1, v12
v_lshlrev_b32 v13, 1, v13
v_lshrrev_b32 v12, 1, v12
v_or_b32 v12, v12, v13
v_lshlrev_b32 v12, 5, v12
v_and_b32 v13, 7, v1
v_lshlrev_b32 v13, 2, v13
v_add_u32 v12, v12, v13
s_lshl_b32 s62, s48, 7
v_add_u32 v162, s62, v12
v_lshrrev_b32 v13, 4, v1
v_lshlrev_b32 v163, 5, v13
s_lshl_b32 s62, s48, 3
v_mov_b32 v161, s62
v_mov_b32 v165, 0
s_waitcnt vmcnt(31)
s_mov_b32 s61, 40000
rh_10018:
v_xor_b32 v14, s56, v32
v_bitop3_b32 v14, v33, s56, v14 bitop3:0xbe
v_bitop3_b32 v14, v34, s56, v14 bitop3:0xbe
v_bitop3_b32 v14, v35, s56, v14 bitop3:0xbe
v_bitop3_b32 v14, v36, s56, v14 bitop3:0xbe
v_bitop3_b32 v14, v37, s56, v14 bitop3:0xbe
v_bitop3_b32 v14, v38, s56, v14 bitop3:0xbe
v_bitop3_b32 v14, v39, s56, v14 bitop3:0xbe
v_and_b32 v14, 0xff, v14
v_cmp_ne_u32 vcc, 0, v14
s_nop 1
s_cbranch_vccz okh_10019
s_sub_u32 s61, s61, 1
s_cbranch_scc1 okh_10019
s_sleep 8
buffer_load_dwordx4 v[32:35], v47, s[44:47], s69 offen sc1
buffer_load_dwordx4 v[36:39], v47, s[44:47], s70 offen sc1
s_waitcnt vmcnt(0)
s_branch rh_10018
okh_10019:
v_permlane32_swap_b32 v32, v33
v_permlane32_swap_b32 v34, v35
v_add_f32 v32, v32, v33
v_add_f32 v34, v34, v35
s_nop 1
v_permlane16_swap_b32 v32, v34
v_add_f32 v32, v32, v34
s_nop 1
v_add_f32_dpp v32, v32, v32 row_ror:8 row_mask:0xf bank_mask:0xf
v_permlane32_swap_b32 v36, v37
v_permlane32_swap_b32 v38, v39
v_add_f32 v36, v36, v37
v_add_f32 v38, v38, v39
s_nop 1
v_permlane16_swap_b32 v36, v38
v_add_f32 v36, v36, v38
s_nop 1
v_add_f32_dpp v36, v36, v36 row_ror:8 row_mask:0xf bank_mask:0xf
v_cvt_pk_bf16_f32 v40, v32, v36
v_lshlrev_b32 v32, 16, v40
v_and_b32 v33, 0xffff0000, v40
v_mul_f32 v40, s58, v32
v_exp_f32 v40, -v40
s_nop 0
v_add_f32 v40, 1.0, v40
v_rcp_f32 v40, v40
s_nop 0
v_mul_f32 v32, v32, v40
v_cvt_pk_bf16_f32 v40, v32, v32
v_lshlrev_b32 v32, 16, v40
v_mul_f32 v32, v32, v33
v_cvt_pk_bf16_f32 v32, v32, v32
v_lshrrev_b32 v12, 4, v1
v_and_b32 v13, 1, v12
v_lshlrev_b32 v13, 1, v13
v_lshrrev_b32 v12, 1, v12
v_or_b32 v12, v12, v13
v_lshlrev_b32 v12, 5, v12
v_and_b32 v13, 7, v1
v_lshlrev_b32 v13, 2, v13
v_add_u32 v13, v13, v12
ds_write_b32 v13, v32 offset:12544
v_lshrrev_b32 v13, 4, v1
v_lshlrev_b32 v13, 5, v13
s_waitcnt lgkmcnt(0)
ds_read_b128 v[16:19], v13 offset:12544
ds_read_b128 v[20:23], v13 offset:12560
s_waitcnt lgkmcnt(0)
s_waitcnt vmcnt(17)
v_and_b32 v64, v16, v4
v_and_b32 v65, v16, v5
v_and_b32 v66, v16, v6
v_and_b32 v67, v16, v7
v_and_b32 v68, v17, v4
v_and_b32 v69, v17, v5
v_and_b32 v70, v17, v6
v_and_b32 v71, v17, v7
v_mfma_f32_16x16x32_bf16 v[124:127], v[64:67], a[0:3], 0
v_mfma_f32_16x16x32_bf16 v[116:119], v[64:67], a[28:31], 0
v_and_b32 v72, v18, v4
v_and_b32 v73, v18, v5
v_and_b32 v74, v18, v6
v_and_b32 v75, v18, v7
v_mfma_f32_16x16x32_bf16 v[124:127], v[68:71], a[4:7], v[124:127]
v_mfma_f32_16x16x32_bf16 v[116:119], v[68:71], a[32:35], v[116:119]
v_and_b32 v76, v19, v4
v_and_b32 v77, v19, v5
v_and_b32 v78, v19, v6
v_and_b32 v79, v19, v7
v_mfma_f32_16x16x32_bf16 v[124:127], v[72:75], a[8:11], v[124:127]
v_mfma_f32_16x16x32_bf16 v[116:119], v[72:75], a[36:39], v[116:119]
v_and_b32 v64, v20, v4
v_and_b32 v65, v20, v5
v_and_b32 v66, v20, v6
v_and_b32 v67, v20, v7
v_mfma_f32_16x16x32_bf16 v[124:127], v[76:79], a[12:15], v[124:127]
v_mfma_f32_16x16x32_bf16 v[116:119], v[76:79], a[40:43], v[116:119]
v_and_b32 v68, v21, v4
v_and_b32 v69, v21, v5
v_and_b32 v70, v21, v6
v_and_b32 v71, v21, v7
v_mfma_f32_16x16x32_bf16 v[124:127], v[64:67], a[16:19], v[124:127]
v_mfma_f32_16x16x32_bf16 v[116:119], v[64:67], a[44:47], v[116:119]
v_and_b32 v72, v22, v4
v_and_b32 v73, v22, v5
v_and_b32 v74, v22, v6
v_and_b32 v75, v22, v7
v_mfma_f32_16x16x32_bf16 v[124:127], v[68:71], a[20:23], v[124:127]
v_mfma_f32_16x16x32_bf16 v[116:119], v[68:71], a[48:51], v[116:119]
v_mfma_f32_16x16x32_bf16 v[124:127], v[72:75], a[24:27], v[124:127]
v_mfma_f32_16x16x32_bf16 v[116:119], v[72:75], a[52:55], v[116:119]
buffer_load_dwordx4 v[96:99], v30, s[44:47], s74 offen sc1
buffer_load_dwordx4 v[104:107], v29, s[44:47], s76 offen sc1
s_add_u32 s51, s74, 33792
buffer_load_dwordx4 v[100:103], v30, s[44:47], s51 offen sc1
s_add_u32 s51, s76, 33792
buffer_load_dwordx4 v[108:111], v29, s[44:47], s51 offen sc1
s_nop 0
v_bfi_b32 v124, s57, v8, v124
v_bfi_b32 v125, s57, v8, v125
v_bfi_b32 v126, s57, v8, v126
v_bfi_b32 v127, s57, v8, v127
v_bfi_b32 v116, s57, v8, v116
v_bfi_b32 v117, s57, v8, v117
v_bfi_b32 v118, s57, v8, v118
v_bfi_b32 v119, s57, v8, v119
s_add_u32 s51, s72, 65536
s_mov_b32 exec_hi, 0
buffer_store_dwordx4 v[124:127], v160, s[44:47], s72 offen sc1
buffer_store_dwordx4 v[116:119], v160, s[44:47], s51 offen sc1
s_mov_b64 exec, -1
s_waitcnt vmcnt(2)
s_mov_b32 s61, 40000
rg2_10020:
v_xor_b32 v14, s55, v106
v_bitop3_b32 v14, v107, s55, v14 bitop3:0xbe
v_bitop3_b32 v14, v110, s55, v14 bitop3:0xbe
v_bitop3_b32 v14, v111, s55, v14 bitop3:0xbe
v_xor_b32 v15, s56, v96
v_bitop3_b32 v15, v97, s56, v15 bitop3:0xbe
v_bitop3_b32 v15, v98, s56, v15 bitop3:0xbe
v_bitop3_b32 v15, v99, s56, v15 bitop3:0xbe
v_bitop3_b32 v15, v100, s56, v15 bitop3:0xbe
v_bitop3_b32 v15, v101, s56, v15 bitop3:0xbe
v_bitop3_b32 v15, v102, s56, v15 bitop3:0xbe
v_bitop3_b32 v15, v103, s56, v15 bitop3:0xbe
v_bitop3_b32 v15, v104, s56, v15 bitop3:0xbe
v_bitop3_b32 v15, v105, s56, v15 bitop3:0xbe
v_bitop3_b32 v15, v108, s56, v15 bitop3:0xbe
v_bitop3_b32 v15, v109, s56, v15 bitop3:0xbe
v_and_or_b32 v15, v15, s57, v14
v_cmp_ne_u32 vcc, 0, v15
s_nop 1
s_cbranch_vccz okg2_10021
s_sub_u32 s61, s61, 1
s_cbranch_scc1 okg2_10021
buffer_load_dwordx4 v[96:99], v30, s[44:47], s74 offen sc1
buffer_load_dwordx4 v[104:107], v29, s[44:47], s76 offen sc1
s_add_u32 s51, s74, 33792
buffer_load_dwordx4 v[100:103], v30, s[44:47], s51 offen sc1
s_add_u32 s51, s76, 33792
buffer_load_dwordx4 v[108:111], v29, s[44:47], s51 offen sc1
s_waitcnt vmcnt(0)
s_branch rg2_10020
okg2_10021:
v_and_b32 v104, 0xffffff00, v104
v_and_b32 v108, 0xffffff00, v108
v_max_f32 v120, v104, v108
s_nop 1
v_max_f32_dpp v120, v120, v120 row_ror:8 row_mask:0xf bank_mask:0xf
v_mov_b32 v121, v120
s_nop 1
v_permlane16_swap_b32 v120, v121
v_max_f32 v120, v120, v121
v_mov_b32 v121, v120
s_nop 1
v_permlane32_swap_b32 v120, v121
v_max_f32 v120, v120, v121
v_sub_f32 v104, v104, v120
v_sub_f32 v108, v108, v120
v_mul_f32 v104, s58, v104
v_mul_f32 v108, s58, v108
v_exp_f32 v104, v104
v_exp_f32 v108, v108
v_mul_f32 v96, v104, v96
v_mul_f32 v97, v104, v97
v_mul_f32 v98, v104, v98
v_mul_f32 v99, v104, v99
v_mul_f32 v105, v104, v105
v_fmac_f32 v96, v108, v100
v_fmac_f32 v97, v108, v101
v_fmac_f32 v98, v108, v102
v_fmac_f32 v99, v108, v103
v_fmac_f32 v105, v108, v109
v_mov_b32 v121, v105
s_nop 1
v_permlane32_swap_b32 v105, v121
v_add_f32 v105, v105, v121
v_mov_b32 v121, v105
s_nop 1
v_permlane16_swap_b32 v105, v121
v_add_f32 v105, v105, v121
s_nop 1
v_add_f32_dpp v105, v105, v105 row_ror:8 row_mask:0xf bank_mask:0xf
v_permlane32_swap_b32 v96, v97
v_permlane32_swap_b32 v98, v99
v_add_f32 v96, v96, v97
v_add_f32 v98, v98, v99
s_nop 1
v_permlane16_swap_b32 v96, v98
v_add_f32 v96, v96, v98
s_nop 1
v_add_f32_dpp v96, v96, v96 row_ror:8 row_mask:0xf bank_mask:0xf
v_mov_b32 v121, v105
ds_write_b32 v162, v96 offset:13312
ds_write_b64 v161, v[120:121] offset:14848
s_waitcnt lgkmcnt(0)
s_barrier
ds_read_b128 v[100:103], v165 offset:14848
ds_read_b128 v[104:107], v165 offset:14864
ds_read_b128 v[32:35], v163 offset:13312
ds_read_b128 v[36:39], v163 offset:13328
ds_read_b128 v[40:43], v163 offset:13440
ds_read_b128 v[44:47], v163 offset:13456
ds_read_b128 v[48:51], v163 offset:13568
ds_read_b128 v[52:55], v163 offset:13584
ds_read_b128 v[56:59], v163 offset:13696
ds_read_b128 v[60:63], v163 offset:13712
s_waitcnt lgkmcnt(8)
v_max3_f32 v120, v100, v102, v104
v_max_f32 v120, v120, v106
v_sub_f32 v100, v100, v120
v_sub_f32 v102, v102, v120
v_sub_f32 v104, v104, v120
v_sub_f32 v106, v106, v120
v_mul_f32 v100, s58, v100
v_mul_f32 v102, s58, v102
v_mul_f32 v104, s58, v104
v_mul_f32 v106, s58, v106
v_exp_f32 v100, v100
v_exp_f32 v102, v102
v_exp_f32 v104, v104
v_exp_f32 v106, v106
v_mul_f32 v121, v100, v101
v_fmac_f32 v121, v102, v103
v_fmac_f32 v121, v104, v105
v_fmac_f32 v121, v106, v107
v_rcp_f32 v121, v121
s_nop 0
v_mul_f32 v100, v100, v121
v_mul_f32 v102, v102, v121
v_mul_f32 v104, v104, v121
v_mul_f32 v106, v106, v121
v_mov_b32 v101, v100
v_mov_b32 v103, v102
v_mov_b32 v105, v104
v_mov_b32 v107, v106
s_waitcnt lgkmcnt(6)
v_pk_mul_f32 v[32:33], v[100:101], v[32:33]
v_pk_mul_f32 v[34:35], v[100:101], v[34:35]
v_pk_mul_f32 v[36:37], v[100:101], v[36:37]
v_pk_mul_f32 v[38:39], v[100:101], v[38:39]
s_waitcnt lgkmcnt(4)
v_pk_fma_f32 v[32:33], v[102:103], v[40:41], v[32:33]
v_pk_fma_f32 v[34:35], v[102:103], v[42:43], v[34:35]
v_pk_fma_f32 v[36:37], v[102:103], v[44:45], v[36:37]
v_pk_fma_f32 v[38:39], v[102:103], v[46:47], v[38:39]
s_waitcnt lgkmcnt(2)
v_pk_fma_f32 v[32:33], v[104:105], v[48:49], v[32:33]
v_pk_fma_f32 v[34:35], v[104:105], v[50:51], v[34:35]
v_pk_fma_f32 v[36:37], v[104:105], v[52:53], v[36:37]
v_pk_fma_f32 v[38:39], v[104:105], v[54:55], v[38:39]
s_waitcnt lgkmcnt(0)
v_pk_fma_f32 v[32:33], v[106:107], v[56:57], v[32:33]
v_pk_fma_f32 v[34:35], v[106:107], v[58:59], v[34:35]
v_pk_fma_f32 v[36:37], v[106:107], v[60:61], v[36:37]
v_pk_fma_f32 v[38:39], v[106:107], v[62:63], v[38:39]
v_cvt_pk_bf16_f32 v16, v32, v32
v_cvt_pk_bf16_f32 v17, v33, v33
v_cvt_pk_bf16_f32 v18, v34, v34
v_cvt_pk_bf16_f32 v19, v35, v35
v_cvt_pk_bf16_f32 v20, v36, v36
v_cvt_pk_bf16_f32 v21, v37, v37
v_cvt_pk_bf16_f32 v22, v38, v38
v_cvt_pk_bf16_f32 v23, v39, v39
s_waitcnt vmcnt(6)
v_and_b32 v64, v16, v4
v_and_b32 v65, v16, v5
v_and_b32 v66, v16, v6
v_and_b32 v67, v16, v7
v_and_b32 v68, v17, v4
v_and_b32 v69, v17, v5
v_and_b32 v70, v17, v6
v_and_b32 v71, v17, v7
v_mfma_f32_16x16x32_bf16 v[124:127], v[64:67], a[64:67], 0
v_mfma_f32_16x16x32_bf16 v[116:119], v[64:67], a[96:99], 0
v_and_b32 v72, v18, v4
v_and_b32 v73, v18, v5
v_and_b32 v74, v18, v6
v_and_b32 v75, v18, v7
v_mfma_f32_16x16x32_bf16 v[124:127], v[68:71], a[68:71], v[124:127]
v_mfma_f32_16x16x32_bf16 v[116:119], v[68:71], a[100:103], v[116:119]
v_and_b32 v76, v19, v4
v_and_b32 v77, v19, v5
v_and_b32 v78, v19, v6
v_and_b32 v79, v19, v7
v_mfma_f32_16x16x32_bf16 v[124:127], v[72:75], a[72:75], v[124:127]
v_mfma_f32_16x16x32_bf16 v[116:119], v[72:75], a[104:107], v[116:119]
v_and_b32 v64, v20, v4
v_and_b32 v65, v20, v5
v_and_b32 v66, v20, v6
v_and_b32 v67, v20, v7
v_mfma_f32_16x16x32_bf16 v[124:127], v[76:79], a[76:79], v[124:127]
v_mfma_f32_16x16x32_bf16 v[116:119], v[76:79], a[108:111], v[116:119]
v_and_b32 v68, v21, v4
v_and_b32 v69, v21, v5
v_and_b32 v70, v21, v6
v_and_b32 v71, v21, v7
v_mfma_f32_16x16x32_bf16 v[124:127], v[64:67], a[80:83], v[124:127]
v_mfma_f32_16x16x32_bf16 v[116:119], v[64:67], a[112:115], v[116:119]
v_and_b32 v72, v22, v4
v_and_b32 v73, v22, v5
v_and_b32 v74, v22, v6
v_and_b32 v75, v22, v7
v_mfma_f32_16x16x32_bf16 v[124:127], v[68:71], a[84:87], v[124:127]
v_mfma_f32_16x16x32_bf16 v[116:119], v[68:71], a[116:119], v[116:119]
v_and_b32 v76, v23, v4
v_and_b32 v77, v23, v5
v_and_b32 v78, v23, v6
v_and_b32 v79, v23, v7
v_mfma_f32_16x16x32_bf16 v[124:127], v[72:75], a[88:91], v[124:127]
v_mfma_f32_16x16x32_bf16 v[116:119], v[72:75], a[120:123], v[116:119]
v_mfma_f32_16x16x32_bf16 v[124:127], v[76:79], a[92:95], v[124:127]
v_mfma_f32_16x16x32_bf16 v[116:119], v[76:79], a[124:127], v[116:119]
s_nop 6
v_bfi_b32 v124, s57, v8, v124
v_bfi_b32 v125, s57, v8, v125
v_bfi_b32 v126, s57, v8, v126
v_bfi_b32 v127, s57, v8, v127
v_bfi_b32 v116, s57, v8, v116
v_bfi_b32 v117, s57, v8, v117
v_bfi_b32 v118, s57, v8, v118
v_bfi_b32 v119, s57, v8, v119
s_add_u32 s51, s73, 65536
s_mov_b32 exec_hi, 0
buffer_store_dwordx4 v[124:127], v160, s[44:47], s73 offen sc1
buffer_store_dwordx4 v[116:119], v160, s[44:47], s51 offen sc1
s_mov_b64 exec, -1
s_branch final_10015
norole_10014:
s_waitcnt vmcnt(24)
v_perm_b32 v64, v132, v128, s53
v_perm_b32 v65, v140, v136, s53
v_perm_b32 v66, v148, v144, s53
v_perm_b32 v67, v156, v152, s53
v_perm_b32 v68, v132, v128, s54
v_perm_b32 v69, v140, v136, s54
v_perm_b32 v70, v148, v144, s54
v_perm_b32 v71, v156, v152, s54
v_mfma_f32_16x16x32_bf16 v[96:99], v[64:67], v[48:51], v[96:99]
v_perm_b32 v72, v133, v129, s53
v_perm_b32 v73, v141, v137, s53
v_perm_b32 v74, v149, v145, s53
v_perm_b32 v75, v157, v153, s53
v_mfma_f32_16x16x32_bf16 v[100:103], v[68:71], v[48:51], v[100:103]
v_perm_b32 v76, v133, v129, s54
v_perm_b32 v77, v141, v137, s54
v_perm_b32 v78, v149, v145, s54
v_perm_b32 v79, v157, v153, s54
v_mfma_f32_16x16x32_bf16 v[104:107], v[72:75], v[48:51], v[104:107]
v_perm_b32 v80, v134, v130, s53
v_perm_b32 v81, v142, v138, s53
v_perm_b32 v82, v150, v146, s53
v_perm_b32 v83, v158, v154, s53
v_mfma_f32_16x16x32_bf16 v[108:111], v[76:79], v[48:51], v[108:111]
v_perm_b32 v84, v134, v130, s54
v_perm_b32 v85, v142, v138, s54
v_perm_b32 v86, v150, v146, s54
v_perm_b32 v87, v158, v154, s54
v_mfma_f32_16x16x32_bf16 v[112:115], v[80:83], v[48:51], v[112:115]
v_perm_b32 v88, v135, v131, s53
v_perm_b32 v89, v143, v139, s53
v_perm_b32 v90, v151, v147, s53
v_perm_b32 v91, v159, v155, s53
v_mfma_f32_16x16x32_bf16 v[116:119], v[84:87], v[48:51], v[116:119]
v_perm_b32 v92, v135, v131, s54
v_perm_b32 v93, v143, v139, s54
v_perm_b32 v94, v151, v147, s54
v_perm_b32 v95, v159, v155, s54
v_mfma_f32_16x16x32_bf16 v[120:123], v[88:91], v[48:51], v[120:123]
s_nop 0
v_mfma_f32_16x16x32_bf16 v[124:127], v[92:95], v[48:51], v[124:127]
s_waitcnt vmcnt(16)
v_perm_b32 v64, v164, v160, s53
v_perm_b32 v65, v172, v168, s53
v_perm_b32 v66, v180, v176, s53
v_perm_b32 v67, v188, v184, s53
v_perm_b32 v68, v164, v160, s54
v_perm_b32 v69, v172, v168, s54
v_perm_b32 v70, v180, v176, s54
v_perm_b32 v71, v188, v184, s54
v_mfma_f32_16x16x32_bf16 v[96:99], v[64:67], v[52:55], v[96:99]
v_perm_b32 v72, v165, v161, s53
v_perm_b32 v73, v173, v169, s53
v_perm_b32 v74, v181, v177, s53
v_perm_b32 v75, v189, v185, s53
v_mfma_f32_16x16x32_bf16 v[100:103], v[68:71], v[52:55], v[100:103]
v_perm_b32 v76, v165, v161, s54
v_perm_b32 v77, v173, v169, s54
v_perm_b32 v78, v181, v177, s54
v_perm_b32 v79, v189, v185, s54
v_mfma_f32_16x16x32_bf16 v[104:107], v[72:75], v[52:55], v[104:107]
v_perm_b32 v80, v166, v162, s53
v_perm_b32 v81, v174, v170, s53
v_perm_b32 v82, v182, v178, s53
v_perm_b32 v83, v190, v186, s53
v_mfma_f32_16x16x32_bf16 v[108:111], v[76:79], v[52:55], v[108:111]
v_perm_b32 v84, v166, v162, s54
v_perm_b32 v85, v174, v170, s54
v_perm_b32 v86, v182, v178, s54
v_perm_b32 v87, v190, v186, s54
v_mfma_f32_16x16x32_bf16 v[112:115], v[80:83], v[52:55], v[112:115]
v_perm_b32 v88, v167, v163, s53
v_perm_b32 v89, v175, v171, s53
v_perm_b32 v90, v183, v179, s53
v_perm_b32 v91, v191, v187, s53
v_mfma_f32_16x16x32_bf16 v[116:119], v[84:87], v[52:55], v[116:119]
v_perm_b32 v92, v167, v163, s54
v_perm_b32 v93, v175, v171, s54
v_perm_b32 v94, v183, v179, s54
v_perm_b32 v95, v191, v187, s54
v_mfma_f32_16x16x32_bf16 v[120:123], v[88:91], v[52:55], v[120:123]
s_nop 0
v_mfma_f32_16x16x32_bf16 v[124:127], v[92:95], v[52:55], v[124:127]
s_waitcnt vmcnt(8)
v_perm_b32 v64, v196, v192, s53
v_perm_b32 v65, v204, v200, s53
v_perm_b32 v66, v212, v208, s53
v_perm_b32 v67, v220, v216, s53
v_perm_b32 v68, v196, v192, s54
v_perm_b32 v69, v204, v200, s54
v_perm_b32 v70, v212, v208, s54
v_perm_b32 v71, v220, v216, s54
v_mfma_f32_16x16x32_bf16 v[96:99], v[64:67], v[56:59], v[96:99]
v_perm_b32 v72, v197, v193, s53
v_perm_b32 v73, v205, v201, s53
v_perm_b32 v74, v213, v209, s53
v_perm_b32 v75, v221, v217, s53
v_mfma_f32_16x16x32_bf16 v[100:103], v[68:71], v[56:59], v[100:103]
v_perm_b32 v76, v197, v193, s54
v_perm_b32 v77, v205, v201, s54
v_perm_b32 v78, v213, v209, s54
v_perm_b32 v79, v221, v217, s54
v_mfma_f32_16x16x32_bf16 v[104:107], v[72:75], v[56:59], v[104:107]
v_perm_b32 v80, v198, v194, s53
v_perm_b32 v81, v206, v202, s53
v_perm_b32 v82, v214, v210, s53
v_perm_b32 v83, v222, v218, s53
v_mfma_f32_16x16x32_bf16 v[108:111], v[76:79], v[56:59], v[108:111]
v_perm_b32 v84, v198, v194, s54
v_perm_b32 v85, v206, v202, s54
v_perm_b32 v86, v214, v210, s54
v_perm_b32 v87, v222, v218, s54
v_mfma_f32_16x16x32_bf16 v[112:115], v[80:83], v[56:59], v[112:115]
v_perm_b32 v88, v199, v195, s53
v_perm_b32 v89, v207, v203, s53
v_perm_b32 v90, v215, v211, s53
v_perm_b32 v91, v223, v219, s53
v_mfma_f32_16x16x32_bf16 v[116:119], v[84:87], v[56:59], v[116:119]
v_perm_b32 v92, v199, v195, s54
v_perm_b32 v93, v207, v203, s54
v_perm_b32 v94, v215, v211, s54
v_perm_b32 v95, v223, v219, s54
v_mfma_f32_16x16x32_bf16 v[120:123], v[88:91], v[56:59], v[120:123]
s_nop 0
v_mfma_f32_16x16x32_bf16 v[124:127], v[92:95], v[56:59], v[124:127]
s_waitcnt vmcnt(0)
v_perm_b32 v64, v228, v224, s53
v_perm_b32 v65, v236, v232, s53
v_perm_b32 v66, v244, v240, s53
v_perm_b32 v67, v252, v248, s53
v_perm_b32 v68, v228, v224, s54
v_perm_b32 v69, v236, v232, s54
v_perm_b32 v70, v244, v240, s54
v_perm_b32 v71, v252, v248, s54
v_mfma_f32_16x16x32_bf16 v[96:99], v[64:67], v[60:63], v[96:99]
v_perm_b32 v72, v229, v225, s53
v_perm_b32 v73, v237, v233, s53
v_perm_b32 v74, v245, v241, s53
v_perm_b32 v75, v253, v249, s53
v_mfma_f32_16x16x32_bf16 v[100:103], v[68:71], v[60:63], v[100:103]
v_perm_b32 v76, v229, v225, s54
v_perm_b32 v77, v237, v233, s54
v_perm_b32 v78, v245, v241, s54
v_perm_b32 v79, v253, v249, s54
v_mfma_f32_16x16x32_bf16 v[104:107], v[72:75], v[60:63], v[104:107]
v_perm_b32 v80, v230, v226, s53
v_perm_b32 v81, v238, v234, s53
v_perm_b32 v82, v246, v242, s53
v_perm_b32 v83, v254, v250, s53
v_mfma_f32_16x16x32_bf16 v[108:111], v[76:79], v[60:63], v[108:111]
v_perm_b32 v84, v230, v226, s54
v_perm_b32 v85, v238, v234, s54
v_perm_b32 v86, v246, v242, s54
v_perm_b32 v87, v254, v250, s54
v_mfma_f32_16x16x32_bf16 v[112:115], v[80:83], v[60:63], v[112:115]
v_perm_b32 v88, v231, v227, s53
v_perm_b32 v89, v239, v235, s53
v_perm_b32 v90, v247, v243, s53
v_perm_b32 v91, v255, v251, s53
v_mfma_f32_16x16x32_bf16 v[116:119], v[84:87], v[60:63], v[116:119]
v_perm_b32 v92, v231, v227, s54
v_perm_b32 v93, v239, v235, s54
v_perm_b32 v94, v247, v243, s54
v_perm_b32 v95, v255, v251, s54
v_mfma_f32_16x16x32_bf16 v[120:123], v[88:91], v[60:63], v[120:123]
s_nop 0
v_mfma_f32_16x16x32_bf16 v[124:127], v[92:95], v[60:63], v[124:127]
v_xor_b32 v88, 0, v24
v_xor_b32 v89, 16, v24
v_xor_b32 v90, 32, v24
v_xor_b32 v91, 48, v24
v_xor_b32 v92, 64, v24
v_xor_b32 v93, 80, v24
v_xor_b32 v94, 96, v24
v_xor_b32 v95, 112, v24
s_mov_b32 exec_lo, 0x00ff00ff
s_mov_b32 exec_hi, 0x00ff00ff
ds_write_b128 v88, v[96:99]
ds_write_b128 v89, v[100:103]
ds_write_b128 v90, v[104:107]
ds_write_b128 v91, v[108:111]
ds_write_b128 v92, v[112:115]
ds_write_b128 v93, v[116:119]
ds_write_b128 v94, v[120:123]
ds_write_b128 v95, v[124:127]
s_mov_b64 exec, -1
s_waitcnt lgkmcnt(0)
s_barrier
ds_read_b128 v[64:67], v25 offset:16384
ds_read_b128 v[68:71], v25 offset:20480
ds_read_b128 v[72:75], v25 offset:24576
ds_read_b128 v[76:79], v25 offset:28672
s_waitcnt lgkmcnt(3)
v_pk_mul_f32 v[64:65], v[16:17], v[64:65]
v_pk_mul_f32 v[66:67], v[16:17], v[66:67]
s_waitcnt lgkmcnt(2)
v_pk_fma_f32 v[64:65], v[18:19], v[68:69], v[64:65]
v_pk_fma_f32 v[66:67], v[18:19], v[70:71], v[66:67]
s_waitcnt lgkmcnt(1)
v_pk_fma_f32 v[64:65], v[20:21], v[72:73], v[64:65]
v_pk_fma_f32 v[66:67], v[20:21], v[74:75], v[66:67]
s_waitcnt lgkmcnt(0)
v_pk_fma_f32 v[64:65], v[22:23], v[76:77], v[64:65]
v_pk_fma_f32 v[66:67], v[22:23], v[78:79], v[66:67]
v_bfi_b32 v64, s57, v8, v64
v_bfi_b32 v65, s57, v8, v65
v_bfi_b32 v66, s57, v8, v66
v_bfi_b32 v67, s57, v8, v67
buffer_store_dwordx4 v[64:67], v26, s[44:47], s71 offen sc1
final_10015:
s_mov_b32 s75, s2
s_cmp_ge_u32 s2, 32
s_cbranch_scc1 fin_10017
s_lshl_b32 s62, s75, 14
s_lshl_b32 s65, s48, 12
s_add_u32 s62, s62, s65
s_add_u32 s70, s62, 2097152
s_add_u32 s69, s62, 2621440
v_lshrrev_b32 v12, 4, v1
v_and_b32 v13, 1, v12
v_lshlrev_b32 v13, 1, v13
v_lshrrev_b32 v12, 1, v12
v_or_b32 v12, v12, v13
v_and_b32 v14, 7, v1
v_lshlrev_b32 v14, 2, v14
v_add_u32 v14, v14, v12
v_lshlrev_b32 v179, 1, v14
s_lshl_b32 s74, s75, 6
v_lshlrev_b32 v183, 2, v14
s_lshl_b32 s65, s48, 7
v_add_u32 v182, s65, v183
buffer_load_ushort v181, v179, s[4:7], s74 offen
buffer_load_dwordx4 v[128:131], v3, s[44:47], s69 offen offset:0 sc1
buffer_load_dwordx4 v[132:135], v3, s[44:47], s69 offen offset:1024 sc1
buffer_load_dwordx4 v[136:139], v3, s[44:47], s69 offen offset:2048 sc1
buffer_load_dwordx4 v[140:143], v3, s[44:47], s69 offen offset:3072 sc1
s_waitcnt vmcnt(0)
s_mov_b32 s61, 40000
rfb_10022:
v_xor_b32 v15, s56, v128
v_bitop3_b32 v15, v129, s56, v15 bitop3:0xbe
v_bitop3_b32 v15, v130, s56, v15 bitop3:0xbe
v_bitop3_b32 v15, v131, s56, v15 bitop3:0xbe
v_bitop3_b32 v15, v132, s56, v15 bitop3:0xbe
v_bitop3_b32 v15, v133, s56, v15 bitop3:0xbe
v_bitop3_b32 v15, v134, s56, v15 bitop3:0xbe
v_bitop3_b32 v15, v135, s56, v15 bitop3:0xbe
v_bitop3_b32 v15, v136, s56, v15 bitop3:0xbe
v_bitop3_b32 v15, v137, s56, v15 bitop3:0xbe
v_bitop3_b32 v15, v138, s56, v15 bitop3:0xbe
v_bitop3_b32 v15, v139, s56, v15 bitop3:0xbe
v_bitop3_b32 v15, v140, s56, v15 bitop3:0xbe
v_bitop3_b32 v15, v141, s56, v15 bitop3:0xbe
v_bitop3_b32 v15, v142, s56, v15 bitop3:0xbe
v_bitop3_b32 v15, v143, s56, v15 bitop3:0xbe
v_and_b32 v15, 0xff, v15
v_cmp_ne_u32 vcc, 0, v15
s_nop 1
s_cbranch_vccz okfb_10023
s_sub_u32 s61, s61, 1
s_cbranch_scc1 okfb_10023
s_sleep 2
buffer_load_dwordx4 v[128:131], v3, s[44:47], s69 offen offset:0 sc1
buffer_load_dwordx4 v[132:135], v3, s[44:47], s69 offen offset:1024 sc1
buffer_load_dwordx4 v[136:139], v3, s[44:47], s69 offen offset:2048 sc1
buffer_load_dwordx4 v[140:143], v3, s[44:47], s69 offen offset:3072 sc1
s_waitcnt vmcnt(0)
s_branch rfb_10022
okfb_10023:
buffer_load_dwordx4 v[144:147], v3, s[44:47], s70 offen offset:0 sc1
buffer_load_dwordx4 v[148:151], v3, s[44:47], s70 offen offset:1024 sc1
buffer_load_dwordx4 v[152:155], v3, s[44:47], s70 offen offset:2048 sc1
buffer_load_dwordx4 v[156:159], v3, s[44:47], s70 offen offset:3072 sc1
v_pk_add_f32 v[128:129], v[128:129], v[132:133]
v_pk_add_f32 v[136:137], v[136:137], v[140:141]
v_pk_add_f32 v[130:131], v[130:131], v[134:135]
v_pk_add_f32 v[138:139], v[138:139], v[142:143]
v_pk_add_f32 v[128:129], v[128:129], v[136:137]
v_pk_add_f32 v[130:131], v[130:131], v[138:139]
s_nop 0
v_permlane32_swap_b32 v128, v129
v_permlane32_swap_b32 v130, v131
v_add_f32 v128, v128, v129
v_add_f32 v130, v130, v131
s_nop 1
v_permlane16_swap_b32 v128, v130
v_add_f32 v128, v128, v130
s_nop 1
v_add_f32_dpp v128, v128, v128 row_ror:8 row_mask:0xf bank_mask:0xf
ds_write_b32 v182, v128 offset:13824
s_waitcnt lgkmcnt(0)
s_barrier
ds_read_b32 v128, v183 offset:13824
ds_read_b32 v129, v183 offset:13952
ds_read_b32 v130, v183 offset:14080
ds_read_b32 v131, v183 offset:14208
s_waitcnt lgkmcnt(0)
v_add_f32 v128, v128, v129
v_add_f32 v130, v130, v131
v_add_f32 v128, v128, v130
v_cvt_pk_bf16_f32 v128, v128, v128
v_lshlrev_b32 v128, 16, v128
v_mul_f32 v40, s58, v128
v_exp_f32 v40, -v40
s_nop 0
v_add_f32 v40, 1.0, v40
v_rcp_f32 v40, v40
s_nop 0
v_mul_f32 v32, v128, v40
v_cvt_pk_bf16_f32 v32, v32, v32
v_lshlrev_b32 v32, 16, v32
v_lshlrev_b32 v44, 16, v181
s_waitcnt vmcnt(0)
s_mov_b32 s61, 40000
rfs_10024:
v_xor_b32 v15, s56, v144
v_bitop3_b32 v15, v145, s56, v15 bitop3:0xbe
v_bitop3_b32 v15, v146, s56, v15 bitop3:0xbe
v_bitop3_b32 v15, v147, s56, v15 bitop3:0xbe
v_bitop3_b32 v15, v148, s56, v15 bitop3:0xbe
v_bitop3_b32 v15, v149, s56, v15 bitop3:0xbe
v_bitop3_b32 v15, v150, s56, v15 bitop3:0xbe
v_bitop3_b32 v15, v151, s56, v15 bitop3:0xbe
v_bitop3_b32 v15, v152, s56, v15 bitop3:0xbe
v_bitop3_b32 v15, v153, s56, v15 bitop3:0xbe
v_bitop3_b32 v15, v154, s56, v15 bitop3:0xbe
v_bitop3_b32 v15, v155, s56, v15 bitop3:0xbe
v_bitop3_b32 v15, v156, s56, v15 bitop3:0xbe
v_bitop3_b32 v15, v157, s56, v15 bitop3:0xbe
v_bitop3_b32 v15, v158, s56, v15 bitop3:0xbe
v_bitop3_b32 v15, v159, s56, v15 bitop3:0xbe
v_and_b32 v15, 0xff, v15
v_cmp_ne_u32 vcc, 0, v15
s_nop 1
s_cbranch_vccz okfs_10025
s_sub_u32 s61, s61, 1
s_cbranch_scc1 okfs_10025
buffer_load_dwordx4 v[144:147], v3, s[44:47], s70 offen offset:0 sc1
buffer_load_dwordx4 v[148:151], v3, s[44:47], s70 offen offset:1024 sc1
buffer_load_dwordx4 v[152:155], v3, s[44:47], s70 offen offset:2048 sc1
buffer_load_dwordx4 v[156:159], v3, s[44:47], s70 offen offset:3072 sc1
s_waitcnt vmcnt(0)
s_branch rfs_10024
okfs_10025:
v_pk_add_f32 v[144:145], v[144:145], v[148:149]
v_pk_add_f32 v[152:153], v[152:153], v[156:157]
v_pk_add_f32 v[146:147], v[146:147], v[150:151]
v_pk_add_f32 v[154:155], v[154:155], v[158:159]
v_pk_add_f32 v[144:145], v[144:145], v[152:153]
v_pk_add_f32 v[146:147], v[146:147], v[154:155]
s_nop 0
v_permlane32_swap_b32 v144, v145
v_permlane32_swap_b32 v146, v147
v_add_f32 v144, v144, v145
v_add_f32 v146, v146, v147
s_nop 1
v_permlane16_swap_b32 v144, v146
v_add_f32 v144, v144, v146
s_nop 1
v_add_f32_dpp v144, v144, v144 row_ror:8 row_mask:0xf bank_mask:0xf
ds_write_b32 v182, v144 offset:14336
s_waitcnt lgkmcnt(0)
s_barrier
ds_read_b32 v144, v183 offset:14336
ds_read_b32 v145, v183 offset:14464
ds_read_b32 v146, v183 offset:14592
ds_read_b32 v147, v183 offset:14720
s_waitcnt lgkmcnt(0)
v_add_f32 v144, v144, v145
v_add_f32 v146, v146, v147
v_add_f32 v144, v144, v146
v_cvt_pk_bf16_f32 v144, v144, v144
v_lshlrev_b32 v144, 16, v144
v_mul_f32 v36, v144, v32
v_cvt_pk_bf16_f32 v36, v36, v36
v_lshlrev_b32 v36, 16, v36
v_add_f32 v36, v36, v44
v_cvt_pk_bf16_f32 v40, v36, v36
s_cmp_lg_u32 s48, 0
s_cbranch_scc1 out_10026
s_mov_b32 exec_lo, 0x00ff00ff
s_mov_b32 exec_hi, 0x00ff00ff
buffer_store_short v40, v179, s[36:39], s74 offen
s_cmp_lg_u32 s75, 0
s_cbranch_scc1 out_10026
v_mov_b32 v12, 0
v_mov_b32 v13, s55
s_mov_b32 exec_lo, 1
s_mov_b32 exec_hi, 0
buffer_store_dword v13, v12, s[44:47], 0 offen sc1
out_10026:
s_mov_b64 exec, -1
fin_10017:
end_10001:
s_endpgm
.section .rodata,"a"
.p2align 6
.amdhsa_kernel recurrent_scan__gqa_block_cached__glu_gated_swiglu__decode_kernel
  .amdhsa_next_free_vgpr 512
  .amdhsa_next_free_sgpr 102
  .amdhsa_accum_offset 256
  .amdhsa_group_segment_fixed_size 0
  .amdhsa_kernarg_size 96
  .amdhsa_user_sgpr_count 2
  .amdhsa_user_sgpr_kernarg_segment_ptr 1
  .amdhsa_system_sgpr_workgroup_id_x 1
  .amdhsa_float_denorm_mode_32 3
.end_amdhsa_kernel
```
